```python
import torch

def _softmax(x, axis=-1):
    return torch.softmax(x, dim=axis)
def _gelu(x):
    return torch.nn.functional.gelu(x, approximate="tanh")
def _silu(x):
    return torch.nn.functional.silu(x)
def _sigmoid(x):
    return torch.sigmoid(x)
def _layernorm(x, axis=-1, eps=1e-5):
    m = x.mean(dim=axis, keepdim=True)
    v = x.var(dim=axis, keepdim=True, unbiased=False)
    return (x - m) / torch.sqrt(v + eps)
def _scatter_add(tgt, idx, src, axis=0):
    return tgt.clone().index_add_(axis, idx, src)
def _segment_sum(src, seg, n):
    out = torch.zeros((n,) + src.shape[1:], dtype=src.dtype)
    return out.index_add_(0, seg, src)
def _pad(x, pw):
    flat = tuple(v for pair in reversed(pw) for v in pair)
    return torch.nn.functional.pad(x, flat)

kernel_name = 'concat_heads__softmax_full_mha__ssm_conv_h3__prompt'

def setup_inputs():

    _w = (lambda a: (lambda t: t.to(torch.bfloat16) if t.is_floating_point() else t)(torch.as_tensor(a)))
    def _A_setup():
        B, S, D = 1, 2048, 448
        return {
            "x": _w((lambda *s: torch.randn(*s, dtype=torch.bfloat16) * 0.2)(B, S, D)),
            "wqkv": _w((lambda *s: torch.randn(*s, dtype=torch.bfloat16) * 0.2)(D, 3 * D)),
            "wo": _w((lambda *s: torch.randn(*s, dtype=torch.bfloat16) * 0.05)(D, D)),
        }
    _A_in = _A_setup()

    def _B_setup():
        B, S, D = 1, 2048, 448
        ks = 4
        return {
            "q": _w((lambda *s: torch.randn(*s, dtype=torch.bfloat16) * 0.05)(B, S, D)),
            "k": _w((lambda *s: torch.randn(*s, dtype=torch.bfloat16) * 0.4)(B, S, D)),
            "v": _w((lambda *s: torch.randn(*s, dtype=torch.bfloat16) * 0.4)(B, S, D)),
            "shift_k": _w((lambda *s: torch.randn(*s, dtype=torch.bfloat16) * 0.4)(D, ks) * 0.5),
            "ssm_k": _w((lambda *s: torch.randn(*s, dtype=torch.bfloat16) * 0.8)(D, S) * (1.0 / S ** 0.5)),
            "ssm_D": _w((lambda *s: torch.randn(*s, dtype=torch.bfloat16) * 0.4)(D)),
        }
    _B_in = _B_setup()

    return {
        "A_x": _A_in["x"],
        "A_wqkv": _A_in["wqkv"],
        "A_wo": _A_in["wo"],
        "B_q": _B_in["q"],
        "B_k": _B_in["k"],
        "B_v": _B_in["v"],
        "B_shift_k": _B_in["shift_k"],
        "B_ssm_k": _B_in["ssm_k"],
        "B_ssm_D": _B_in["ssm_D"],
    }

def reference(A_x, A_wqkv, A_wo, B_q, B_k, B_v, B_shift_k, B_ssm_k, B_ssm_D):
    def _A_ref(x, wqkv, wo):
        B, S, D = x.shape
        H = 16; Dh = D // H
        qkv = (lambda x, *d: x.permute(*d))((x @ wqkv).reshape(B, S, 3, H, Dh), 2, 0, 3, 1, 4)
        q, k, v = qkv[0], qkv[1], qkv[2]
        scale = Dh ** -0.5
        scores = torch.einsum("bhqd,bhkd->bhqk", q, k) * scale
        p = _softmax(scores, axis=-1)
        o = torch.einsum("bhqk,bhkd->bhqd", p, v)
        return (lambda x, *d: x.permute(*d))(o, 0, 2, 1, 3).reshape(B, S, D) @ wo

    def _B_ref(q, k, v, shift_k, ssm_k, ssm_D):
        B, S, D = q.shape
        ks = shift_k.shape[-1]
        k_pad = _pad(k, ((0, 0), (ks - 1, 0), (0, 0)))
        k_shift = torch.zeros_like(k)
        for t in range(ks):
            k_shift = k_shift + k_pad[:, t:t + S, :] * shift_k[:, ks - 1 - t][None, None, :]
        kv = k_shift * v
        L = 2 * S
        kv_pad = _pad(kv, ((0, 0), (0, S), (0, 0)))
        kf_pad = _pad(ssm_k, ((0, 0), (0, S)))
        kv_f = (lambda x, axes=(-2,-1): torch.fft.rfft2(x.float(), dim=axes))(kv_pad[:, None, :, :], axes=(1, 2))
        kf_f = (lambda x, axes=(-2,-1): torch.fft.rfft2(x.float(), dim=axes))(kf_pad[:, None, :], axes=(1, 2))
        kf_f = (lambda x, *d: x.permute(*d))(kf_f, 1, 2, 0)
        y_f = kv_f * kf_f[None, :, :, :]
        y = (lambda x, s, axes=(-2,-1): torch.fft.irfft2(x, s=s, dim=axes).to(torch.bfloat16))(y_f, (1, L), axes=(1, 2))[:, 0, :S, :]
        y = y + kv * ssm_D[None, None, :]
        return q * y

    a = _A_ref(A_x, A_wqkv, A_wo)
    b = _B_ref(B_q, B_k, B_v, B_shift_k, B_ssm_k, B_ssm_D)
    return torch.concatenate([a, b], axis=-1)
```

```asm
; @launch grid=(256,1,1) block=(512,1,1) lds=161536
.amdgcn_target "amdgcn-amd-amdhsa--gfx950"
.text
.globl concat_heads__softmax_full_mha__ssm_conv_h3__prompt_kernel
.p2align 8
.type concat_heads__softmax_full_mha__ssm_conv_h3__prompt_kernel,@function
.set CODE_BYTES, L_hot_end - concat_heads__softmax_full_mha__ssm_conv_h3__prompt_kernel - 16
concat_heads__softmax_full_mha__ssm_conv_h3__prompt_kernel:
  s_cmp_ge_u32 s2, 256
  s_cbranch_scc1 L_end
  s_getpc_b64 s[60:61]
  s_load_dwordx16 s[4:19], s[0:1], 0
  s_load_dwordx8 s[20:27], s[0:1], 64
  s_bfe_u32 s52, s2, 0x20003
  s_lshl_b32 s52, s52, 6
  v_lshrrev_b32 v2, 3, v0
  v_add_lshl_u32 v2, v2, s52, 7
  v_min_u32 v2, CODE_BYTES, v2
  global_load_dword v254, v2, s[60:61]
  v_lshrrev_b32 v3, 6, v0
  v_and_b32 v1, 63, v0
  v_readfirstlane_b32 s3, v3
  v_mov_b32 v4, 158464
  v_lshl_add_u32 v4, v0, 2, v4
  v_mov_b32 v5, 0
  ds_write2st64_b32 v4, v5, v5 offset1:4
  s_and_b32 s52, s2, 1
  s_lshl_b32 s52, s52, 3
  s_bfe_u32 s53, s2, 0x30003
  s_add_u32 s29, s52, s53
  s_bfe_u32 s52, s2, 0x20001
  s_lshl_b32 s52, s52, 2
  s_lshr_b32 s53, s2, 6
  s_add_u32 s30, s52, s53
  s_and_b32 s28, s3, 3
  s_lshl_b32 s53, s53, 1
  s_and_b32 s56, s2, 1
  s_add_u32 s56, s56, 1
  s_and_b32 s52, s29, 7
  s_xor_b32 s62, s52, s56
  s_add_u32 s53, s53, s52
  s_sub_u32 s52, s53, 7
  s_cselect_b32 s53, s53, s52
  s_mov_b32 s34, 16777216
  s_mov_b32 s35, 0x20000
  s_mov_b32 s39, 0x20000
  s_cmp_lt_u32 s3, 4
  s_cselect_b32 s57, 3, 5
  s_sub_u32 s57, s57, s56
  s_and_b32 s58, s29, 7
  s_and_b32 s59, s30, 3
  s_mul_i32 s60, s59, 7
  s_add_u32 s60, s60, s58
  s_add_u32 s59, s59, 28
  s_cmp_gt_u32 s58, s57
  s_subb_u32 s60, s60, 0
  s_cmp_eq_u32 s58, s57
  s_cselect_b32 s60, s59, s60
  s_and_b32 s2, s2, 7
  s_lshl3_add_u32 s2, s60, s2
  v_lshrrev_b32 v6, 3, v1
  v_lshrrev_b32 v7, 4, v1
  v_and_b32 v8, 7, v1
  v_xor_b32 v9, v8, v7
  v_and_b32 v7, 1, v7
  v_lshlrev_b32 v7, 2, v7
  v_xor_b32 v8, v8, v7
  v_mul_u32_u24 v26, 2688, v6
  v_lshl_add_u32 v26, v8, 4, v26
  v_add_u32 v27, 20480, v26
  v_mul_u32_u24 v6, 896, v6
  v_lshl_add_u32 v28, v9, 4, v6
  v_xor_b32 v29, 64, v28
  v_add_u32 v29, 6144, v29
  v_add_u32 v30, 12288, v28
  v_add_u32 v31, 12288, v29
  s_mul_i32 s55, s56, 896
  s_lshl_b32 s56, s62, 7
  s_add_u32 s55, s55, s56
  s_mul_i32 s58, s28, 43008
  s_add_u32 s55, s55, s58
  s_cmp_eq_u32 s62, 7
  s_cselect_b32 s55, 1073741824, s55
  s_lshl_b32 s52, s30, 2
  s_add_u32 s52, s52, s28
  s_mul_i32 s52, s52, 28672
  s_lshl_b32 s54, s28, 12
  s_lshl_b32 s57, s28, 11
  s_mov_b32 s38, 1204224
  s_mov_b32 s46, 1835008
  s_mov_b32 s47, 0x20000
  s_cmp_lt_u32 s3, 4
  s_waitcnt lgkmcnt(0)
  s_load_dword s31, s[26:27], 0
  s_barrier
  s_cbranch_scc1 L_A
  s_setprio 3
  s_mov_b32 s36, s6
  s_mov_b32 s37, s7
  s_mov_b32 s44, s4
  s_mov_b32 s45, s5
  s_add_u32 m0, s57, 0
  s_mul_i32 s56, s53, 172032
  s_add_u32 s56, s56, s55
  buffer_load_dwordx4 v26, s[36:39], s56 offen offset:0 lds
  buffer_load_dwordx4 v27, s[36:39], s56 offen offset:1024 lds
  s_add_u32 m0, s54, 57344
  s_lshl_b32 s56, s53, 7
  s_add_u32 s56, s56, s52
  buffer_load_dwordx4 v28, s[44:47], s56 offen offset:0 lds
  buffer_load_dwordx4 v29, s[44:47], s56 offen offset:1024 lds
  buffer_load_dwordx4 v30, s[44:47], s56 offen offset:2048 lds
  buffer_load_dwordx4 v31, s[44:47], s56 offen offset:3072 lds
  s_add_u32 s53, s53, 1
  s_cmp_eq_u32 s53, 7
  s_cselect_b32 s53, 0, s53
  s_add_u32 m0, s57, 8192
  s_mul_i32 s56, s53, 172032
  s_add_u32 s56, s56, s55
  buffer_load_dwordx4 v26, s[36:39], s56 offen offset:0 lds
  buffer_load_dwordx4 v27, s[36:39], s56 offen offset:1024 lds
  s_setprio 1
  v_lshl_add_u32 v24, v8, 4, v6
  v_lshrrev_b32 v4, 2, v1
  v_and_b32 v5, 3, v1
  v_lshlrev_b32 v13, 4, v1
  s_lshl_b32 s56, s28, 2
  s_add_u32 s56, s56, 159488
  v_add_u32 v250, s56, v13
  v_add_u32 v249, 0x200, v250
  v_xor_b32 v251, 4, v249
  s_mov_b32 s56, 158464
  v_lshl_add_u32 v246, v1, 2, s56
  s_mov_b32 s32, s26
  s_mov_b32 s33, s27
  s_lshr_b32 s58, s28, 1
  s_and_b32 s59, s28, 1
  s_lshl_b32 s61, s59, 11
  v_add_u32 v247, s61, v13
  v_subrev_u32 v244, 4, v247
  v_add_u32 v245, 1020, v247
  s_mul_i32 s56, s58, 8320
  s_add_u32 s56, s56, 96288
  v_add_u32 v252, s56, v247
  s_lshl_b32 s61, s2, 1
  s_add_u32 s61, s61, s58
  s_lshl_b32 s61, s61, 12
  s_add_u32 s48, s18, s61
  s_addc_u32 s49, s19, 0
  s_cmp_lt_u32 s2, 224
  s_cselect_b32 s50, 4096, 0
  s_mov_b32 s51, 0x20000
  s_min_u32 s61, s2, 223
  s_lshl_b32 s61, s61, 2
  s_load_dword s40, s[20:21], s61
  s_add_u32 m0, s54, 73728
  s_lshl_b32 s56, s53, 7
  s_add_u32 s56, s56, s52
  buffer_load_dwordx4 v28, s[44:47], s56 offen offset:0 lds
  buffer_load_dwordx4 v29, s[44:47], s56 offen offset:1024 lds
  buffer_load_dwordx4 v30, s[44:47], s56 offen offset:2048 lds
  buffer_load_dwordx4 v31, s[44:47], s56 offen offset:3072 lds
  s_add_u32 s53, s53, 1
  s_cmp_eq_u32 s53, 7
  s_cselect_b32 s53, 0, s53
  s_mul_i32 s60, s28, 4608
  s_add_u32 s60, s60, 77824
  s_mul_i32 s61, s28, 2176
  s_add_u32 s61, s61, 149760
  s_lshr_b32 s56, s2, 4
  s_lshl_b32 s56, s56, 13
  s_add_u32 s56, s56, 262144
  s_lshl_b32 s62, s28, 11
  s_add_u32 s56, s56, s62
  v_lshl_add_u32 v6, v4, 7, s56
  v_lshlrev_b32 v7, 7, v4
  v_lshl_add_u32 v7, v5, 4, v7
  s_lshl_b32 s56, s2, 13
  s_lshl_b32 s62, s58, 6
  s_add_u32 s56, s56, s62
  v_add_u32 v7, s56, v7
  v_and_b32 v8, 15, v1
  v_lshrrev_b32 v9, 4, v1
  v_lshlrev_b32 v11, 5, v8
  v_lshlrev_b32 v12, 4, v9
  v_sub_u32 v17, v11, v12
  s_lshl_b32 s56, s59, 8
  s_sub_u32 s62, s60, s56
  s_add_u32 s62, s62, 336
  v_add_u32 v17, s62, v17
  v_lshl_add_u32 v18, v9, 3, v11
  v_add_u32 v18, s61, v18
  v_lshl_add_u32 v9, v9, 3, v8
  v_sub_u32 v9, 15, v9
  v_lshrrev_b32 v11, 1, v8
  v_lshl_add_u32 v11, v11, 2, v12
  v_and_b32 v8, 1, v9
  v_lshlrev_b32 v10, 4, v8
  v_mul_u32_u24 v8, 4160, v8
  v_add_u32 v11, v11, v8
  s_mul_i32 s62, s58, 8320
  s_add_u32 s62, s62, s56
  s_add_u32 s62, s62, 96260
  v_add_u32 v20, s62, v11
  v_add_u32 v21, 1024, v20
  v_add_u32 v22, 2048, v20
  v_add_u32 v23, 3072, v20
  v_lshrrev_b32 v9, 1, v9
  s_waitcnt lgkmcnt(0)
  s_add_u32 s31, s31, 0x9e3779b9
  s_lshl_b32 s56, s58, 4
  s_lshr_b32 s40, s40, s56
  s_and_b32 s40, s40, 0xffff
  s_cmp_eq_u32 s59, 0
  s_cselect_b32 s40, s40, 0
  v_lshlrev_b32 v10, v10, s40
  v_mov_b32 v3, s31
  v_cmp_eq_u32 vcc, 0, v9
  s_nop 1
  v_cndmask_b32 v60, 0, v10, vcc
  v_cmp_eq_u32 vcc, 1, v9
  s_nop 1
  v_cndmask_b32 v61, 0, v10, vcc
  v_cmp_eq_u32 vcc, 2, v9
  s_nop 1
  v_cndmask_b32 v62, 0, v10, vcc
  v_cmp_eq_u32 vcc, 3, v9
  s_nop 1
  v_cndmask_b32 v63, 0, v10, vcc
  s_add_u32 m0, s57, 16384
  s_mul_i32 s56, s53, 172032
  s_add_u32 s56, s56, s55
  buffer_load_dwordx4 v26, s[36:39], s56 offen offset:0 lds
  buffer_load_dwordx4 v27, s[36:39], s56 offen offset:1024 lds
  v_mov_b32 v12, 1
  s_waitcnt vmcnt(8)
  ds_write_b32 v250, v12
  s_add_u32 m0, s54, 90112
  s_lshl_b32 s56, s53, 7
  s_add_u32 s56, s56, s52
  buffer_load_dwordx4 v28, s[44:47], s56 offen offset:0 lds
  buffer_load_dwordx4 v29, s[44:47], s56 offen offset:1024 lds
  buffer_load_dwordx4 v30, s[44:47], s56 offen offset:2048 lds
  buffer_load_dwordx4 v31, s[44:47], s56 offen offset:3072 lds
  s_add_u32 s53, s53, 1
  s_cmp_eq_u32 s53, 7
  s_cselect_b32 s53, 0, s53
  s_add_u32 m0, s57, 24576
  s_mul_i32 s56, s53, 172032
  s_add_u32 s56, s56, s55
  buffer_load_dwordx4 v26, s[36:39], s56 offen offset:0 lds
  buffer_load_dwordx4 v27, s[36:39], s56 offen offset:1024 lds
  v_mov_b32 v12, 2
  s_waitcnt vmcnt(8)
  ds_write_b32 v250, v12
  s_add_u32 m0, s54, 106496
  s_lshl_b32 s56, s53, 7
  s_add_u32 s56, s56, s52
  buffer_load_dwordx4 v28, s[44:47], s56 offen offset:0 lds
  buffer_load_dwordx4 v29, s[44:47], s56 offen offset:1024 lds
  buffer_load_dwordx4 v30, s[44:47], s56 offen offset:2048 lds
  buffer_load_dwordx4 v31, s[44:47], s56 offen offset:3072 lds
  s_add_u32 s53, s53, 1
  s_cmp_eq_u32 s53, 7
  s_cselect_b32 s53, 0, s53
  s_add_u32 m0, s57, 32768
  s_mul_i32 s56, s53, 172032
  s_add_u32 s56, s56, s55
  buffer_load_dwordx4 v26, s[36:39], s56 offen offset:0 lds
  buffer_load_dwordx4 v27, s[36:39], s56 offen offset:1024 lds
  v_mov_b32 v12, 3
  s_waitcnt vmcnt(8)
  ds_write_b32 v250, v12
  s_add_u32 m0, s54, 122880
  s_lshl_b32 s56, s53, 7
  s_add_u32 s56, s56, s52
  buffer_load_dwordx4 v28, s[44:47], s56 offen offset:0 lds
  buffer_load_dwordx4 v29, s[44:47], s56 offen offset:1024 lds
  buffer_load_dwordx4 v30, s[44:47], s56 offen offset:2048 lds
  buffer_load_dwordx4 v31, s[44:47], s56 offen offset:3072 lds
  s_add_u32 s53, s53, 1
  s_cmp_eq_u32 s53, 7
  s_cselect_b32 s53, 0, s53
  buffer_load_dwordx4 v[32:35], v247, s[48:51], 0 offen offset:0
  buffer_load_dword v40, v244, s[48:51], 0 offen
  buffer_load_dwordx4 v[36:39], v247, s[48:51], 0 offen offset:1024
  buffer_load_dword v41, v245, s[48:51], 0 offen
  s_add_u32 m0, s57, 40960
  s_mul_i32 s56, s53, 172032
  s_add_u32 s56, s56, s55
  buffer_load_dwordx4 v26, s[36:39], s56 offen offset:0 lds
  buffer_load_dwordx4 v27, s[36:39], s56 offen offset:1024 lds
  v_mov_b32 v12, 4
  s_waitcnt vmcnt(12)
  ds_write_b32 v250, v12
  s_mov_b32 s63, 65536
L_ls1:
  ds_read_b32 v12, v246
  s_sub_u32 s63, s63, 1
  s_cbranch_scc1 L_ls1_x
  s_waitcnt lgkmcnt(0)
  v_cmp_gt_u32 vcc, 1, v12
  s_cbranch_vccnz L_ls1
L_ls1_x:
  s_add_u32 m0, s54, 139264
  s_lshl_b32 s56, s53, 7
  s_add_u32 s56, s56, s52
  buffer_load_dwordx4 v28, s[44:47], s56 offen offset:0 lds
  buffer_load_dwordx4 v29, s[44:47], s56 offen offset:1024 lds
  buffer_load_dwordx4 v30, s[44:47], s56 offen offset:2048 lds
  buffer_load_dwordx4 v31, s[44:47], s56 offen offset:3072 lds
  s_add_u32 s53, s53, 1
  s_cmp_eq_u32 s53, 7
  s_cselect_b32 s53, 0, s53
  s_add_u32 m0, s57, 49152
  s_mul_i32 s56, s53, 172032
  s_add_u32 s56, s56, s55
  buffer_load_dwordx4 v26, s[36:39], s56 offen offset:0 lds
  buffer_load_dwordx4 v27, s[36:39], s56 offen offset:1024 lds
  v_mov_b32 v12, 5
  s_waitcnt vmcnt(12)
  ds_write_b32 v250, v12
  s_add_u32 m0, s54, 57344
  s_lshl_b32 s56, s53, 7
  s_add_u32 s56, s56, s52
  buffer_load_dwordx4 v28, s[44:47], s56 offen offset:0 lds
  buffer_load_dwordx4 v29, s[44:47], s56 offen offset:1024 lds
  buffer_load_dwordx4 v30, s[44:47], s56 offen offset:2048 lds
  buffer_load_dwordx4 v31, s[44:47], s56 offen offset:3072 lds
  s_add_u32 s53, s53, 1
  s_cmp_eq_u32 s53, 7
  s_cselect_b32 s53, 0, s53
  s_cmp_lt_u32 s2, 224
  s_cbranch_scc1 L_ssm
  v_mov_b32 v12, 6
  s_waitcnt vmcnt(6)
  ds_write_b32 v250, v12
  v_mov_b32 v12, 7
  s_waitcnt vmcnt(0)
  ds_write_b32 v250, v12
L_end:
  s_endpgm
L_ssm:
  buffer_load_dword v14, v6, s[32:35], 0 offen sc1
  v_mov_b32 v12, 6
  s_waitcnt vmcnt(7)
  ds_write_b32 v250, v12
  s_mov_b32 s63, 65536
L_ls2:
  ds_read_b32 v12, v246
  s_sub_u32 s63, s63, 1
  s_cbranch_scc1 L_ls2_x
  s_waitcnt lgkmcnt(0)
  v_cmp_gt_u32 vcc, 4, v12
  s_cbranch_vccnz L_ls2
L_ls2_x:
  v_mov_b32 v12, 7
  s_waitcnt vmcnt(1)
  ds_write_b32 v250, v12
  s_mul_i32 s56, s28, 4160
  s_add_u32 s56, s56, 96256
  v_and_b32 v11, 7, v1
  v_lshl_add_u32 v11, v11, 2, s56
  v_mov_b32 v8, 0
  v_mov_b32 v9, 0
  v_lshl_add_u32 v12, v1, 3, s60
  ds_write_b32 v11, v8
  ds_write_b64 v12, v[8:9]
  ds_write_b128 v252, v[32:35] offset:0
  v_alignbit_b32 v44, v32, v40, 16
  v_alignbit_b32 v45, v33, v32, 16
  v_alignbit_b32 v46, v34, v33, 16
  v_alignbit_b32 v47, v35, v34, 16
  ds_write_b128 v252, v[44:47] offset:4160
  ds_write_b128 v252, v[36:39] offset:1024
  v_alignbit_b32 v48, v36, v41, 16
  v_alignbit_b32 v49, v37, v36, 16
  v_alignbit_b32 v50, v38, v37, 16
  v_alignbit_b32 v51, v39, v38, 16
  ds_write_b128 v252, v[48:51] offset:5184
  s_waitcnt vmcnt(0)
  v_cmp_ne_u32 vcc, s31, v14
  s_cbranch_vccz L_f2ok
  s_mov_b32 s63, 65536
  s_branch L_poll3_i
L_poll3:
  s_sleep 4
L_poll3_i:
  buffer_load_dword v12, v6, s[32:35], 0 offen sc1
  s_sub_u32 s63, s63, 1
  s_cbranch_scc1 L_poll3_x
  s_waitcnt vmcnt(0)
  v_cmp_ne_u32 vcc, s31, v12
  s_cbranch_vccnz L_poll3
L_poll3_x:
L_f2ok:
  v_mov_b32 v8, 1
  ds_write_b32 v249, v8 offset:512
  s_mov_b32 s63, 65536
L_ls4:
  ds_read_b32 v12, v246 offset:2048
  s_sub_u32 s63, s63, 1
  s_cbranch_scc1 L_ls4_x
  s_waitcnt lgkmcnt(0)
  v_cmp_gt_u32 vcc, 1, v12
  s_cbranch_vccnz L_ls4
L_ls4_x:
  s_mov_b32 s63, 65536
L_ls5:
  ds_read_b32 v12, v246
  s_sub_u32 s63, s63, 1
  s_cbranch_scc1 L_ls5_x
  s_waitcnt lgkmcnt(0)
  v_cmp_gt_u32 vcc, 8, v12
  s_cbranch_vccnz L_ls5
L_ls5_x:
  s_add_u32 m0, s60, 512
  s_mov_b32 s56, 8388608
  buffer_load_dwordx4 v7, s[32:35], s56 offen offset:0  lds
  s_add_u32 s56, s56, 1024
  buffer_load_dwordx4 v7, s[32:35], s56 offen offset:1024  lds
  s_add_u32 s56, s56, 1024
  buffer_load_dwordx4 v7, s[32:35], s56 offen offset:2048  lds
  s_add_u32 s56, s56, 1024
  buffer_load_dwordx4 v7, s[32:35], s56 offen offset:3072  lds
  s_add_u32 s56, s56, 1024
  ds_read2_b32 v[64:65], v20 offset0:0 offset1:1
  ds_read2_b32 v[66:67], v20 offset0:2 offset1:3
  ds_read2_b32 v[68:69], v20 offset0:128 offset1:129
  ds_read2_b32 v[70:71], v20 offset0:130 offset1:131
  ds_read2_b32 v[72:73], v21 offset0:0 offset1:1
  ds_read2_b32 v[74:75], v21 offset0:2 offset1:3
  ds_read2_b32 v[76:77], v21 offset0:128 offset1:129
  ds_read2_b32 v[78:79], v21 offset0:130 offset1:131
  ds_read2_b32 v[80:81], v22 offset0:0 offset1:1
  ds_read2_b32 v[82:83], v22 offset0:2 offset1:3
  ds_read2_b32 v[84:85], v22 offset0:128 offset1:129
  ds_read2_b32 v[86:87], v22 offset0:130 offset1:131
  ds_read2_b32 v[88:89], v23 offset0:0 offset1:1
  ds_read2_b32 v[90:91], v23 offset0:2 offset1:3
  ds_read2_b32 v[92:93], v23 offset0:128 offset1:129
  ds_read2_b32 v[94:95], v23 offset0:130 offset1:131
  s_lshr_b32 s56, s2, 3
  s_mul_i32 s62, s56, 37
  s_lshr_b32 s62, s62, 8
  s_mul_i32 s52, s62, 7
  s_sub_u32 s52, s56, s52
  s_and_b32 s53, s30, 12
  s_add_u32 s53, s53, s62
  s_lshl_b32 s53, s53, 1
  s_and_b32 s56, s2, 1
  s_add_u32 s53, s53, s56
  s_lshl_b32 s53, s53, 1
  s_add_u32 s53, s53, s59
  s_mov_b32 s36, s8
  s_mov_b32 s37, s9
  s_mov_b32 s38, 401408
  s_mov_b32 s39, 0x20000
  s_xor_b32 s56, s28, 1
  s_mul_i32 s56, s56, 4608
  s_add_u32 s56, s56, 77824
  v_add_u32 v230, s60, v13
  v_add_u32 v231, s56, v13
  v_add_u32 v232, s61, v13
  s_mov_b32 s42, s59
  s_lshl_b32 s41, s59, 12
  s_add_u32 s41, s41, 10485760
  s_lshr_b32 s54, s2, 4
  s_lshl_b32 s54, s54, 1
  s_add_u32 s54, s54, s59
  s_lshl_b32 s54, s54, 5
  s_and_b32 s63, s2, 15
  s_lshl_b32 s63, s63, 1
  s_add_u32 s63, s63, s58
  s_add_u32 s54, s54, s63
  s_lshl_b32 s54, s54, 7
  s_add_u32 s54, s54, 393216
  v_lshl_add_u32 v2, v1, 2, s54
  v_lshrrev_b32 v255, 5, v1
  v_lshl_or_b32 v2, v255, 30, v2
  v_lshrrev_b32 v4, 2, v1
  v_and_b32 v5, 3, v1
  s_and_b32 s59, s2, 31
  s_lshl_b32 s59, s59, 1
  s_and_b32 s56, s28, 1
  s_add_u32 s59, s59, s56
  s_lshr_b32 s60, s2, 5
  s_lshl_b32 s60, s60, 1
  s_lshr_b32 s56, s28, 1
  s_add_u32 s60, s60, s56
  s_mul_i32 s61, s59, 28672
  s_lshl_b32 s56, s60, 6
  s_add_u32 s61, s61, s56
  v_mul_u32_u24 v224, 1792, v4
  v_lshl_add_u32 v224, v5, 4, v224
  v_add_u32 v224, s61, v224
  s_mul_i32 s54, s28, 2176
  s_add_u32 s54, s54, 149760
  v_lshrrev_b32 v225, 5, v1
  v_mul_u32_u24 v225, 544, v225
  v_bfe_u32 v226, v1, 2, 3
  v_lshl_add_u32 v225, v226, 6, v225
  v_lshl_add_u32 v225, v5, 4, v225
  v_add_u32 v225, s54, v225
  v_lshrrev_b32 v226, 3, v1
  v_lshlrev_b32 v226, 13, v226
  v_and_b32 v12, 7, v1
  v_lshl_add_u32 v226, v12, 4, v226
  s_lshl_b32 s56, s60, 17
  s_lshl_b32 s61, s59, 7
  s_add_u32 s56, s56, s61
  v_add_u32 v226, s56, v226
  s_mov_b32 s61, 0xffff0000
  v_mul_u32_u24 v227, 544, v5
  v_lshl_add_u32 v227, v4, 2, v227
  v_add_u32 v227, s54, v227
  s_lshl_b32 s56, s58, 7
  s_lshr_b32 s57, s53, 2
  s_add_u32 s56, s56, s57
  s_lshl_b32 s56, s56, 7
  s_add_u32 s56, s56, 131072
  v_lshl_add_u32 v228, v12, 11, s56
  s_lshl_b32 s56, s60, 1
  s_lshr_b32 s57, s59, 5
  s_add_u32 s56, s56, s57
  s_lshl_b32 s56, s56, 12
  s_add_u32 s56, s56, 393216
  v_and_b32 v229, 31, v1
  v_lshl_add_u32 v229, v229, 7, s56
  v_mov_b32 v9, 2
  v_mov_b32 v9, 3
  s_waitcnt vmcnt(0)
  s_setprio 0
  ds_read_b128 v[128:131], v17 offset:192
  ds_read_b128 v[132:135], v17 offset:704
  ds_read_b128 v[136:139], v17 offset:1216
  ds_read_b128 v[140:143], v17 offset:1728
  ds_read_b128 v[144:147], v17 offset:2240
  ds_read_b128 v[148:151], v17 offset:2752
  ds_read_b128 v[152:155], v17 offset:3264
  ds_read_b128 v[156:159], v17 offset:3776
  s_waitcnt lgkmcnt(0)
  v_mfma_f32_16x16x32_bf16 v[220:223], v[60:63], v[156:159], 0
  ds_read_b128 v[160:163], v17 offset:128
  v_mfma_f32_16x16x32_bf16 v[216:219], v[60:63], v[152:155], 0
  ds_read_b128 v[164:167], v17 offset:640
  v_mfma_f32_16x16x32_bf16 v[212:215], v[60:63], v[148:151], 0
  ds_read_b128 v[168:171], v17 offset:1152
  v_mfma_f32_16x16x32_bf16 v[208:211], v[60:63], v[144:147], 0
  ds_read_b128 v[172:175], v17 offset:1664
  v_mfma_f32_16x16x32_bf16 v[204:207], v[60:63], v[140:143], 0
  ds_read_b128 v[176:179], v17 offset:2176
  v_mfma_f32_16x16x32_bf16 v[200:203], v[60:63], v[136:139], 0
  ds_read_b128 v[180:183], v17 offset:2688
  v_mfma_f32_16x16x32_bf16 v[196:199], v[60:63], v[132:135], 0
  ds_read_b128 v[184:187], v17 offset:3200
  v_mfma_f32_16x16x32_bf16 v[192:195], v[60:63], v[128:131], 0
  ds_read_b128 v[188:191], v17 offset:3712
  v_mfma_f32_16x16x32_bf16 v[220:223], v[64:67], v[156:159], v[220:223]
  ds_read2_b32 v[96:97], v20 offset0:16 offset1:17
  v_mfma_f32_16x16x32_bf16 v[216:219], v[64:67], v[152:155], v[216:219]
  ds_read2_b32 v[98:99], v20 offset0:18 offset1:19
  v_mfma_f32_16x16x32_bf16 v[212:215], v[64:67], v[148:151], v[212:215]
  ds_read2_b32 v[100:101], v20 offset0:144 offset1:145
  v_mfma_f32_16x16x32_bf16 v[208:211], v[64:67], v[144:147], v[208:211]
  ds_read2_b32 v[102:103], v20 offset0:146 offset1:147
  v_mfma_f32_16x16x32_bf16 v[204:207], v[64:67], v[140:143], v[204:207]
  ds_read2_b32 v[104:105], v21 offset0:16 offset1:17
  v_mfma_f32_16x16x32_bf16 v[200:203], v[64:67], v[136:139], v[200:203]
  ds_read2_b32 v[106:107], v21 offset0:18 offset1:19
  v_mfma_f32_16x16x32_bf16 v[196:199], v[64:67], v[132:135], v[196:199]
  ds_read2_b32 v[108:109], v21 offset0:144 offset1:145
  v_mfma_f32_16x16x32_bf16 v[192:195], v[64:67], v[128:131], v[192:195]
  ds_read2_b32 v[110:111], v21 offset0:146 offset1:147
  v_mfma_f32_16x16x32_bf16 v[220:223], v[68:71], v[152:155], v[220:223]
  ds_read2_b32 v[112:113], v22 offset0:16 offset1:17
  v_mfma_f32_16x16x32_bf16 v[216:219], v[68:71], v[148:151], v[216:219]
  ds_read2_b32 v[114:115], v22 offset0:18 offset1:19
  v_mfma_f32_16x16x32_bf16 v[212:215], v[68:71], v[144:147], v[212:215]
  ds_read2_b32 v[116:117], v22 offset0:144 offset1:145
  v_mfma_f32_16x16x32_bf16 v[208:211], v[68:71], v[140:143], v[208:211]
  ds_read2_b32 v[118:119], v22 offset0:146 offset1:147
  v_mfma_f32_16x16x32_bf16 v[204:207], v[68:71], v[136:139], v[204:207]
  ds_read2_b32 v[120:121], v23 offset0:16 offset1:17
  v_mfma_f32_16x16x32_bf16 v[200:203], v[68:71], v[132:135], v[200:203]
  ds_read2_b32 v[122:123], v23 offset0:18 offset1:19
  v_mfma_f32_16x16x32_bf16 v[196:199], v[68:71], v[128:131], v[196:199]
  ds_read2_b32 v[124:125], v23 offset0:144 offset1:145
  v_mfma_f32_16x16x32_bf16 v[220:223], v[72:75], v[148:151], v[220:223]
  ds_read2_b32 v[126:127], v23 offset0:146 offset1:147
  v_mfma_f32_16x16x32_bf16 v[216:219], v[72:75], v[144:147], v[216:219]
  v_mfma_f32_16x16x32_bf16 v[212:215], v[72:75], v[140:143], v[212:215]
  v_mfma_f32_16x16x32_bf16 v[208:211], v[72:75], v[136:139], v[208:211]
  v_mfma_f32_16x16x32_bf16 v[204:207], v[72:75], v[132:135], v[204:207]
  v_mfma_f32_16x16x32_bf16 v[200:203], v[72:75], v[128:131], v[200:203]
  v_mfma_f32_16x16x32_bf16 v[220:223], v[76:79], v[144:147], v[220:223]
  v_mfma_f32_16x16x32_bf16 v[216:219], v[76:79], v[140:143], v[216:219]
  v_mfma_f32_16x16x32_bf16 v[212:215], v[76:79], v[136:139], v[212:215]
  v_mfma_f32_16x16x32_bf16 v[208:211], v[76:79], v[132:135], v[208:211]
  v_mfma_f32_16x16x32_bf16 v[204:207], v[76:79], v[128:131], v[204:207]
  v_mfma_f32_16x16x32_bf16 v[220:223], v[80:83], v[140:143], v[220:223]
  v_mfma_f32_16x16x32_bf16 v[216:219], v[80:83], v[136:139], v[216:219]
  v_mfma_f32_16x16x32_bf16 v[212:215], v[80:83], v[132:135], v[212:215]
  v_mfma_f32_16x16x32_bf16 v[208:211], v[80:83], v[128:131], v[208:211]
  v_mfma_f32_16x16x32_bf16 v[220:223], v[84:87], v[136:139], v[220:223]
  v_mfma_f32_16x16x32_bf16 v[216:219], v[84:87], v[132:135], v[216:219]
  v_mfma_f32_16x16x32_bf16 v[212:215], v[84:87], v[128:131], v[212:215]
  v_mfma_f32_16x16x32_bf16 v[220:223], v[88:91], v[132:135], v[220:223]
  v_mfma_f32_16x16x32_bf16 v[216:219], v[88:91], v[128:131], v[216:219]
  v_mfma_f32_16x16x32_bf16 v[220:223], v[92:95], v[128:131], v[220:223]
  s_waitcnt lgkmcnt(0)
  v_mfma_f32_16x16x32_bf16 v[220:223], v[96:99], v[188:191], v[220:223]
  ds_read_b128 v[128:131], v17 offset:64
  v_mfma_f32_16x16x32_bf16 v[216:219], v[96:99], v[184:187], v[216:219]
  ds_read_b128 v[132:135], v17 offset:576
  v_mfma_f32_16x16x32_bf16 v[212:215], v[96:99], v[180:183], v[212:215]
  ds_read_b128 v[136:139], v17 offset:1088
  v_mfma_f32_16x16x32_bf16 v[208:211], v[96:99], v[176:179], v[208:211]
  ds_read_b128 v[140:143], v17 offset:1600
  v_mfma_f32_16x16x32_bf16 v[204:207], v[96:99], v[172:175], v[204:207]
  ds_read_b128 v[144:147], v17 offset:2112
  v_mfma_f32_16x16x32_bf16 v[200:203], v[96:99], v[168:171], v[200:203]
  ds_read_b128 v[148:151], v17 offset:2624
  v_mfma_f32_16x16x32_bf16 v[196:199], v[96:99], v[164:167], v[196:199]
  ds_read_b128 v[152:155], v17 offset:3136
  v_mfma_f32_16x16x32_bf16 v[192:195], v[96:99], v[160:163], v[192:195]
  ds_read_b128 v[156:159], v17 offset:3648
  v_mfma_f32_16x16x32_bf16 v[220:223], v[100:103], v[184:187], v[220:223]
  ds_read2_b32 v[64:65], v20 offset0:32 offset1:33
  v_mfma_f32_16x16x32_bf16 v[216:219], v[100:103], v[180:183], v[216:219]
  ds_read2_b32 v[66:67], v20 offset0:34 offset1:35
  v_mfma_f32_16x16x32_bf16 v[212:215], v[100:103], v[176:179], v[212:215]
  ds_read2_b32 v[68:69], v20 offset0:160 offset1:161
  v_mfma_f32_16x16x32_bf16 v[208:211], v[100:103], v[172:175], v[208:211]
  ds_read2_b32 v[70:71], v20 offset0:162 offset1:163
  v_mfma_f32_16x16x32_bf16 v[204:207], v[100:103], v[168:171], v[204:207]
  ds_read2_b32 v[72:73], v21 offset0:32 offset1:33
  v_mfma_f32_16x16x32_bf16 v[200:203], v[100:103], v[164:167], v[200:203]
  ds_read2_b32 v[74:75], v21 offset0:34 offset1:35
  v_mfma_f32_16x16x32_bf16 v[196:199], v[100:103], v[160:163], v[196:199]
  ds_read2_b32 v[76:77], v21 offset0:160 offset1:161
  v_mfma_f32_16x16x32_bf16 v[220:223], v[104:107], v[180:183], v[220:223]
  ds_read2_b32 v[78:79], v21 offset0:162 offset1:163
  v_mfma_f32_16x16x32_bf16 v[216:219], v[104:107], v[176:179], v[216:219]
  ds_read2_b32 v[80:81], v22 offset0:32 offset1:33
  v_mfma_f32_16x16x32_bf16 v[212:215], v[104:107], v[172:175], v[212:215]
  ds_read2_b32 v[82:83], v22 offset0:34 offset1:35
  v_mfma_f32_16x16x32_bf16 v[208:211], v[104:107], v[168:171], v[208:211]
  ds_read2_b32 v[84:85], v22 offset0:160 offset1:161
  v_mfma_f32_16x16x32_bf16 v[204:207], v[104:107], v[164:167], v[204:207]
  ds_read2_b32 v[86:87], v22 offset0:162 offset1:163
  v_mfma_f32_16x16x32_bf16 v[200:203], v[104:107], v[160:163], v[200:203]
  ds_read2_b32 v[88:89], v23 offset0:32 offset1:33
  v_mfma_f32_16x16x32_bf16 v[220:223], v[108:111], v[176:179], v[220:223]
  ds_read2_b32 v[90:91], v23 offset0:34 offset1:35
  v_mfma_f32_16x16x32_bf16 v[216:219], v[108:111], v[172:175], v[216:219]
  ds_read2_b32 v[92:93], v23 offset0:160 offset1:161
  v_mfma_f32_16x16x32_bf16 v[212:215], v[108:111], v[168:171], v[212:215]
  ds_read2_b32 v[94:95], v23 offset0:162 offset1:163
  v_mfma_f32_16x16x32_bf16 v[208:211], v[108:111], v[164:167], v[208:211]
  v_mfma_f32_16x16x32_bf16 v[204:207], v[108:111], v[160:163], v[204:207]
  v_mfma_f32_16x16x32_bf16 v[220:223], v[112:115], v[172:175], v[220:223]
  v_mfma_f32_16x16x32_bf16 v[216:219], v[112:115], v[168:171], v[216:219]
  v_mfma_f32_16x16x32_bf16 v[212:215], v[112:115], v[164:167], v[212:215]
  v_mfma_f32_16x16x32_bf16 v[208:211], v[112:115], v[160:163], v[208:211]
  v_mfma_f32_16x16x32_bf16 v[220:223], v[116:119], v[168:171], v[220:223]
  v_mfma_f32_16x16x32_bf16 v[216:219], v[116:119], v[164:167], v[216:219]
  v_mfma_f32_16x16x32_bf16 v[212:215], v[116:119], v[160:163], v[212:215]
  v_mfma_f32_16x16x32_bf16 v[220:223], v[120:123], v[164:167], v[220:223]
  v_mfma_f32_16x16x32_bf16 v[216:219], v[120:123], v[160:163], v[216:219]
  v_mfma_f32_16x16x32_bf16 v[220:223], v[124:127], v[160:163], v[220:223]
  s_waitcnt lgkmcnt(0)
  v_mfma_f32_16x16x32_bf16 v[220:223], v[64:67], v[156:159], v[220:223]
  ds_read_b128 v[160:163], v17 offset:0
  v_mfma_f32_16x16x32_bf16 v[216:219], v[64:67], v[152:155], v[216:219]
  ds_read_b128 v[164:167], v17 offset:512
  v_mfma_f32_16x16x32_bf16 v[212:215], v[64:67], v[148:151], v[212:215]
  ds_read_b128 v[168:171], v17 offset:1024
  v_mfma_f32_16x16x32_bf16 v[208:211], v[64:67], v[144:147], v[208:211]
  ds_read_b128 v[172:175], v17 offset:1536
  v_mfma_f32_16x16x32_bf16 v[204:207], v[64:67], v[140:143], v[204:207]
  ds_read_b128 v[176:179], v17 offset:2048
  v_mfma_f32_16x16x32_bf16 v[200:203], v[64:67], v[136:139], v[200:203]
  ds_read_b128 v[180:183], v17 offset:2560
  v_mfma_f32_16x16x32_bf16 v[196:199], v[64:67], v[132:135], v[196:199]
  ds_read_b128 v[184:187], v17 offset:3072
  v_mfma_f32_16x16x32_bf16 v[192:195], v[64:67], v[128:131], v[192:195]
  ds_read_b128 v[188:191], v17 offset:3584
  v_mfma_f32_16x16x32_bf16 v[220:223], v[68:71], v[152:155], v[220:223]
  ds_read2_b32 v[96:97], v20 offset0:48 offset1:49
  v_mfma_f32_16x16x32_bf16 v[216:219], v[68:71], v[148:151], v[216:219]
  ds_read2_b32 v[98:99], v20 offset0:50 offset1:51
  v_mfma_f32_16x16x32_bf16 v[212:215], v[68:71], v[144:147], v[212:215]
  ds_read2_b32 v[100:101], v20 offset0:176 offset1:177
  v_mfma_f32_16x16x32_bf16 v[208:211], v[68:71], v[140:143], v[208:211]
  ds_read2_b32 v[102:103], v20 offset0:178 offset1:179
  v_mfma_f32_16x16x32_bf16 v[204:207], v[68:71], v[136:139], v[204:207]
  ds_read2_b32 v[104:105], v21 offset0:48 offset1:49
  v_mfma_f32_16x16x32_bf16 v[200:203], v[68:71], v[132:135], v[200:203]
  ds_read2_b32 v[106:107], v21 offset0:50 offset1:51
  v_mfma_f32_16x16x32_bf16 v[196:199], v[68:71], v[128:131], v[196:199]
  ds_read2_b32 v[108:109], v21 offset0:176 offset1:177
  v_mfma_f32_16x16x32_bf16 v[220:223], v[72:75], v[148:151], v[220:223]
  ds_read2_b32 v[110:111], v21 offset0:178 offset1:179
  v_mfma_f32_16x16x32_bf16 v[216:219], v[72:75], v[144:147], v[216:219]
  ds_read2_b32 v[112:113], v22 offset0:48 offset1:49
  v_mfma_f32_16x16x32_bf16 v[212:215], v[72:75], v[140:143], v[212:215]
  ds_read2_b32 v[114:115], v22 offset0:50 offset1:51
  v_mfma_f32_16x16x32_bf16 v[208:211], v[72:75], v[136:139], v[208:211]
  ds_read2_b32 v[116:117], v22 offset0:176 offset1:177
  v_mfma_f32_16x16x32_bf16 v[204:207], v[72:75], v[132:135], v[204:207]
  ds_read2_b32 v[118:119], v22 offset0:178 offset1:179
  v_mfma_f32_16x16x32_bf16 v[200:203], v[72:75], v[128:131], v[200:203]
  ds_read2_b32 v[120:121], v23 offset0:48 offset1:49
  v_mfma_f32_16x16x32_bf16 v[220:223], v[76:79], v[144:147], v[220:223]
  ds_read2_b32 v[122:123], v23 offset0:50 offset1:51
  v_mfma_f32_16x16x32_bf16 v[216:219], v[76:79], v[140:143], v[216:219]
  ds_read2_b32 v[124:125], v23 offset0:176 offset1:177
  v_mfma_f32_16x16x32_bf16 v[212:215], v[76:79], v[136:139], v[212:215]
  ds_read2_b32 v[126:127], v23 offset0:178 offset1:179
  v_mfma_f32_16x16x32_bf16 v[208:211], v[76:79], v[132:135], v[208:211]
  v_mfma_f32_16x16x32_bf16 v[204:207], v[76:79], v[128:131], v[204:207]
  v_mfma_f32_16x16x32_bf16 v[220:223], v[80:83], v[140:143], v[220:223]
  v_mfma_f32_16x16x32_bf16 v[216:219], v[80:83], v[136:139], v[216:219]
  v_mfma_f32_16x16x32_bf16 v[212:215], v[80:83], v[132:135], v[212:215]
  v_mfma_f32_16x16x32_bf16 v[208:211], v[80:83], v[128:131], v[208:211]
  v_mfma_f32_16x16x32_bf16 v[220:223], v[84:87], v[136:139], v[220:223]
  v_mfma_f32_16x16x32_bf16 v[216:219], v[84:87], v[132:135], v[216:219]
  v_mfma_f32_16x16x32_bf16 v[212:215], v[84:87], v[128:131], v[212:215]
  v_mfma_f32_16x16x32_bf16 v[220:223], v[88:91], v[132:135], v[220:223]
  v_mfma_f32_16x16x32_bf16 v[216:219], v[88:91], v[128:131], v[216:219]
  v_mfma_f32_16x16x32_bf16 v[220:223], v[92:95], v[128:131], v[220:223]
  s_waitcnt lgkmcnt(0)
  v_mfma_f32_16x16x32_bf16 v[220:223], v[96:99], v[188:191], v[220:223]
  v_mfma_f32_16x16x32_bf16 v[216:219], v[96:99], v[184:187], v[216:219]
  v_mfma_f32_16x16x32_bf16 v[212:215], v[96:99], v[180:183], v[212:215]
  v_mfma_f32_16x16x32_bf16 v[208:211], v[96:99], v[176:179], v[208:211]
  v_mfma_f32_16x16x32_bf16 v[204:207], v[96:99], v[172:175], v[204:207]
  v_mfma_f32_16x16x32_bf16 v[200:203], v[96:99], v[168:171], v[200:203]
  v_mfma_f32_16x16x32_bf16 v[196:199], v[96:99], v[164:167], v[196:199]
  v_mfma_f32_16x16x32_bf16 v[192:195], v[96:99], v[160:163], v[192:195]
  v_mfma_f32_16x16x32_bf16 v[220:223], v[100:103], v[184:187], v[220:223]
  v_mfma_f32_16x16x32_bf16 v[216:219], v[100:103], v[180:183], v[216:219]
  v_mfma_f32_16x16x32_bf16 v[212:215], v[100:103], v[176:179], v[212:215]
  v_mfma_f32_16x16x32_bf16 v[208:211], v[100:103], v[172:175], v[208:211]
  v_mfma_f32_16x16x32_bf16 v[204:207], v[100:103], v[168:171], v[204:207]
  v_mfma_f32_16x16x32_bf16 v[200:203], v[100:103], v[164:167], v[200:203]
  v_mfma_f32_16x16x32_bf16 v[196:199], v[100:103], v[160:163], v[196:199]
  v_mfma_f32_16x16x32_bf16 v[220:223], v[104:107], v[180:183], v[220:223]
  v_mfma_f32_16x16x32_bf16 v[216:219], v[104:107], v[176:179], v[216:219]
  v_mfma_f32_16x16x32_bf16 v[212:215], v[104:107], v[172:175], v[212:215]
  v_mfma_f32_16x16x32_bf16 v[208:211], v[104:107], v[168:171], v[208:211]
  v_mfma_f32_16x16x32_bf16 v[204:207], v[104:107], v[164:167], v[204:207]
  v_mfma_f32_16x16x32_bf16 v[200:203], v[104:107], v[160:163], v[200:203]
  v_mfma_f32_16x16x32_bf16 v[220:223], v[108:111], v[176:179], v[220:223]
  v_mfma_f32_16x16x32_bf16 v[216:219], v[108:111], v[172:175], v[216:219]
  v_mfma_f32_16x16x32_bf16 v[212:215], v[108:111], v[168:171], v[212:215]
  v_mfma_f32_16x16x32_bf16 v[208:211], v[108:111], v[164:167], v[208:211]
  v_mfma_f32_16x16x32_bf16 v[204:207], v[108:111], v[160:163], v[204:207]
  v_mfma_f32_16x16x32_bf16 v[220:223], v[112:115], v[172:175], v[220:223]
  v_mfma_f32_16x16x32_bf16 v[216:219], v[112:115], v[168:171], v[216:219]
  v_mfma_f32_16x16x32_bf16 v[212:215], v[112:115], v[164:167], v[212:215]
  v_mfma_f32_16x16x32_bf16 v[208:211], v[112:115], v[160:163], v[208:211]
  v_mfma_f32_16x16x32_bf16 v[220:223], v[116:119], v[168:171], v[220:223]
  v_mfma_f32_16x16x32_bf16 v[216:219], v[116:119], v[164:167], v[216:219]
  v_mfma_f32_16x16x32_bf16 v[212:215], v[116:119], v[160:163], v[212:215]
  v_mfma_f32_16x16x32_bf16 v[220:223], v[120:123], v[164:167], v[220:223]
  v_mfma_f32_16x16x32_bf16 v[216:219], v[120:123], v[160:163], v[216:219]
  v_mfma_f32_16x16x32_bf16 v[220:223], v[124:127], v[160:163], v[220:223]
  s_setprio 2
  s_cmp_eq_u32 s42, 0
  s_nop 7
  s_cbranch_scc1 L_lo
  ds_write_b128 v230, v[192:195] offset:0
  ds_write_b128 v230, v[196:199] offset:1024
  ds_write_b128 v230, v[200:203] offset:2048
  ds_write_b128 v230, v[204:207] offset:3072
  ds_write_b32 v249, v9 offset:512
  s_mov_b32 s63, 65536
L_ls6:
  s_sleep 1
  ds_read_b32 v8, v251 offset:512
  s_sub_u32 s63, s63, 1
  s_cbranch_scc1 L_ls6_x
  s_waitcnt lgkmcnt(0)
  v_cmp_gt_u32 vcc, 3, v8
  s_cbranch_vccnz L_ls6
L_ls6_x:
  ds_read_b128 v[64:67], v231 offset:0
  ds_read_b128 v[68:71], v231 offset:1024
  ds_read_b128 v[72:75], v231 offset:2048
  ds_read_b128 v[76:79], v231 offset:3072
  s_waitcnt lgkmcnt(3)
  v_add_f32 v64, v208, v64
  v_add_f32 v65, v209, v65
  v_add_f32 v66, v210, v66
  v_add_f32 v67, v211, v67
  s_waitcnt lgkmcnt(2)
  v_add_f32 v68, v212, v68
  v_add_f32 v69, v213, v69
  v_add_f32 v70, v214, v70
  v_add_f32 v71, v215, v71
  s_waitcnt lgkmcnt(1)
  v_add_f32 v72, v216, v72
  v_add_f32 v73, v217, v73
  v_add_f32 v74, v218, v74
  v_add_f32 v75, v219, v75
  s_waitcnt lgkmcnt(0)
  v_add_f32 v76, v220, v76
  v_add_f32 v77, v221, v77
  v_add_f32 v78, v222, v78
  v_add_f32 v79, v223, v79
  s_branch L_fj
L_lo:
  ds_write_b128 v230, v[208:211] offset:0
  ds_write_b128 v230, v[212:215] offset:1024
  ds_write_b128 v230, v[216:219] offset:2048
  ds_write_b128 v230, v[220:223] offset:3072
  ds_write_b32 v249, v9 offset:512
  s_mov_b32 s63, 65536
L_ls7:
  s_sleep 1
  ds_read_b32 v8, v251 offset:512
  s_sub_u32 s63, s63, 1
  s_cbranch_scc1 L_ls7_x
  s_waitcnt lgkmcnt(0)
  v_cmp_gt_u32 vcc, 3, v8
  s_cbranch_vccnz L_ls7
L_ls7_x:
  ds_read_b128 v[64:67], v231 offset:0
  ds_read_b128 v[68:71], v231 offset:1024
  ds_read_b128 v[72:75], v231 offset:2048
  ds_read_b128 v[76:79], v231 offset:3072
  s_waitcnt lgkmcnt(3)
  v_add_f32 v64, v192, v64
  v_add_f32 v65, v193, v65
  v_add_f32 v66, v194, v66
  v_add_f32 v67, v195, v67
  s_waitcnt lgkmcnt(2)
  v_add_f32 v68, v196, v68
  v_add_f32 v69, v197, v69
  v_add_f32 v70, v198, v70
  v_add_f32 v71, v199, v71
  s_waitcnt lgkmcnt(1)
  v_add_f32 v72, v200, v72
  v_add_f32 v73, v201, v73
  v_add_f32 v74, v202, v74
  v_add_f32 v75, v203, v75
  s_waitcnt lgkmcnt(0)
  v_add_f32 v76, v204, v76
  v_add_f32 v77, v205, v77
  v_add_f32 v78, v206, v78
  v_add_f32 v79, v207, v79
L_fj:
  v_cvt_pk_bf16_f32 v128, v64, v65
  v_cvt_pk_bf16_f32 v129, v66, v67
  ds_write_b64 v18, v[128:129] offset:0
  v_cvt_pk_bf16_f32 v130, v68, v69
  v_cvt_pk_bf16_f32 v131, v70, v71
  ds_write_b64 v18, v[130:131] offset:512
  v_cvt_pk_bf16_f32 v132, v72, v73
  v_cvt_pk_bf16_f32 v133, v74, v75
  ds_write_b64 v18, v[132:133] offset:1024
  v_cvt_pk_bf16_f32 v134, v76, v77
  v_cvt_pk_bf16_f32 v135, v78, v79
  ds_write_b64 v18, v[134:135] offset:1536
  ds_read_b128 v[64:67], v232 offset:0
  ds_read_b128 v[68:71], v232 offset:1024
  s_waitcnt lgkmcnt(1)
  buffer_store_dwordx4 v[64:67], v7, s[32:35], s41 offen offset:0 sc1
  s_waitcnt lgkmcnt(0)
  buffer_store_dwordx4 v[68:71], v7, s[32:35], s41 offen offset:2048 sc1
  s_waitcnt vmcnt(0)
  buffer_store_dword v3, v2, s[32:35], 0 offen sc1
  s_mov_b32 s63, 65536
L_ls8:
  s_sleep 4
  ds_read_b32 v12, v246
  s_sub_u32 s63, s63, 1
  s_cbranch_scc1 L_ls8_x
  s_waitcnt lgkmcnt(0)
  v_cmp_gt_u32 vcc, 11, v12
  s_cbranch_vccnz L_ls8
L_ls8_x:
  s_add_u32 s54, s62, s28
  s_and_b32 s54, s54, 3
  s_mul_i32 s55, s54, 100352
  s_lshl_b32 s56, s52, 7
  s_add_u32 s55, s55, s56
  s_lshr_b32 s56, s54, 1
  s_mul_i32 s56, s56, 35072
  s_mul_i32 s54, s54, 14336
  s_add_u32 s54, s54, s56
  s_add_u32 s54, s54, 49152
  s_add_u32 s57, s54, 14336
L_wo:
  s_mov_b32 m0, s54
  s_add_u32 s54, s54, 1024
  buffer_load_dwordx4 v24, s[36:39], s55 offen lds
  s_add_u32 s55, s55, 7168
  s_waitcnt vmcnt(1)
  s_cmp_lg_u32 s54, s57
  s_cbranch_scc1 L_wo
  global_load_dwordx4 v[32:35], v224, s[10:11]
  global_load_dwordx4 v[36:39], v224, s[10:11] offset:896
  s_mov_b32 s63, 65536
  s_branch L_poll9_i
L_poll9:
  s_sleep 8
L_poll9_i:
  buffer_load_dword v12, v228, s[32:35], 0 offen sc1
  s_sub_u32 s63, s63, 1
  s_cbranch_scc1 L_poll9_x
  s_waitcnt vmcnt(0)
  v_cmp_ne_u32 vcc, s31, v12
  s_cbranch_vccnz L_poll9
L_poll9_x:
  s_mov_b32 s63, 65536
  s_branch L_poll10_i
L_poll10:
  s_sleep 16
L_poll10_i:
  buffer_load_dword v12, v229, s[32:35], 0 offen sc1
  s_sub_u32 s63, s63, 1
  s_cbranch_scc1 L_poll10_x
  s_waitcnt vmcnt(0)
  v_cmp_ne_u32 vcc, s31, v12
  s_cbranch_vccnz L_poll10
L_poll10_x:
  s_mov_b32 s56, 10485760
  s_mov_b32 s57, 10551296
  buffer_load_dwordx4 v[44:47], v226, s[32:35], s56 offen
  buffer_load_dwordx4 v[48:51], v226, s[32:35], s57 offen
  s_mov_b32 s36, s22
  s_mov_b32 s37, s23
  s_mov_b32 s38, 3670016
  s_mov_b32 s39, 0x20000
  s_waitcnt vmcnt(1)
  ds_write_b128 v225, v[44:47] offset:0
  s_waitcnt vmcnt(0)
  ds_write_b128 v225, v[48:51] offset:1088
  ds_read_b32 v52, v227 offset:0
  ds_read_b32 v53, v227 offset:64
  ds_read_b32 v54, v227 offset:128
  ds_read_b32 v55, v227 offset:192
  ds_read_b32 v56, v227 offset:256
  ds_read_b32 v57, v227 offset:320
  ds_read_b32 v58, v227 offset:384
  ds_read_b32 v59, v227 offset:448
  s_waitcnt lgkmcnt(0)
  s_barrier
  s_mul_i32 s56, s59, 28672
  s_add_u32 s56, s56, 896
  v_mul_u32_u24 v19, 1792, v4
  v_add3_u32 v19, v19, v224, s56
  v_lshlrev_b32 v192, 16, v32
  v_and_b32 v193, s61, v32
  v_lshlrev_b32 v194, 16, v33
  v_and_b32 v195, s61, v33
  v_lshlrev_b32 v196, 16, v34
  v_and_b32 v197, s61, v34
  v_lshlrev_b32 v198, 16, v35
  v_and_b32 v199, s61, v35
  v_lshlrev_b32 v200, 16, v36
  v_and_b32 v201, s61, v36
  v_lshlrev_b32 v202, 16, v37
  v_and_b32 v203, s61, v37
  v_lshlrev_b32 v204, 16, v38
  v_and_b32 v205, s61, v38
  v_lshlrev_b32 v206, 16, v39
  v_and_b32 v207, s61, v39
  v_lshlrev_b32 v208, 16, v52
  v_and_b32 v216, s61, v52
  v_lshlrev_b32 v209, 16, v53
  v_and_b32 v217, s61, v53
  v_lshlrev_b32 v210, 16, v54
  v_and_b32 v218, s61, v54
  v_lshlrev_b32 v211, 16, v55
  v_and_b32 v219, s61, v55
  v_lshlrev_b32 v212, 16, v56
  v_and_b32 v220, s61, v56
  v_lshlrev_b32 v213, 16, v57
  v_and_b32 v221, s61, v57
  v_lshlrev_b32 v214, 16, v58
  v_and_b32 v222, s61, v58
  v_lshlrev_b32 v215, 16, v59
  v_and_b32 v223, s61, v59
  v_mul_f32 v208, v208, v192
  v_mul_f32 v209, v209, v193
  v_mul_f32 v210, v210, v194
  v_mul_f32 v211, v211, v195
  v_mul_f32 v212, v212, v196
  v_mul_f32 v213, v213, v197
  v_mul_f32 v214, v214, v198
  v_mul_f32 v215, v215, v199
  v_mul_f32 v216, v216, v200
  v_mul_f32 v217, v217, v201
  v_mul_f32 v218, v218, v202
  v_mul_f32 v219, v219, v203
  v_mul_f32 v220, v220, v204
  v_mul_f32 v221, v221, v205
  v_mul_f32 v222, v222, v206
  v_mul_f32 v223, v223, v207
  v_cvt_pk_bf16_f32 v20, v208, v209
  v_cvt_pk_bf16_f32 v21, v210, v211
  v_cvt_pk_bf16_f32 v22, v212, v213
  v_cvt_pk_bf16_f32 v23, v214, v215
  v_cvt_pk_bf16_f32 v24, v216, v217
  v_cvt_pk_bf16_f32 v25, v218, v219
  v_cvt_pk_bf16_f32 v26, v220, v221
  v_cvt_pk_bf16_f32 v27, v222, v223
  buffer_store_dwordx4 v[20:23], v19, s[36:39], 0 offen offset:0 sc1
  buffer_store_dwordx4 v[24:27], v19, s[36:39], 0 offen offset:1792 sc1
  v_mov_b32 v17, v249
  v_xor_b32 v18, 8, v249
  v_and_b32 v9, 7, v1
  s_lshl_b32 s55, s53, 1
  s_add_u32 s55, s55, s58
  s_lshl_b32 s55, s55, 14
  s_add_u32 s55, s55, 6291456
  s_add_u32 s56, s55, 2044
  v_lshl_add_u32 v6, v9, 11, s56
  v_lshrrev_b32 v12, 5, v1
  v_bfe_u32 v7, v1, 2, 2
  v_lshl_add_u32 v7, v12, 2, v7
  v_lshlrev_b32 v7, 7, v7
  v_lshl_add_u32 v7, v5, 3, v7
  v_bfe_u32 v9, v1, 3, 1
  v_xor_b32 v9, s58, v9
  v_lshl_add_u32 v7, v9, 6, v7
  v_bfe_u32 v9, v1, 4, 1
  v_lshl_add_u32 v7, v9, 5, v7
  s_mul_i32 s56, s58, 63744
  s_add_u32 s56, s56, 49152
  v_add_u32 v7, s56, v7
  v_xor_b32 v10, 64, v7
  ds_read_b64_tr_b16 v[64:65], v7 offset:0
  ds_read_b64_tr_b16 v[68:69], v10 offset:0
  ds_read_b64_tr_b16 v[66:67], v7 offset:1024
  ds_read_b64_tr_b16 v[70:71], v10 offset:1024
  ds_read_b64_tr_b16 v[72:73], v7 offset:2048
  ds_read_b64_tr_b16 v[76:77], v10 offset:2048
  ds_read_b64_tr_b16 v[74:75], v7 offset:3072
  ds_read_b64_tr_b16 v[78:79], v10 offset:3072
  ds_read_b64_tr_b16 v[80:81], v7 offset:3584
  ds_read_b64_tr_b16 v[84:85], v10 offset:3584
  ds_read_b64_tr_b16 v[82:83], v7 offset:4608
  ds_read_b64_tr_b16 v[86:87], v10 offset:4608
  ds_read_b64_tr_b16 v[88:89], v7 offset:5632
  ds_read_b64_tr_b16 v[92:93], v10 offset:5632
  ds_read_b64_tr_b16 v[90:91], v7 offset:6656
  ds_read_b64_tr_b16 v[94:95], v10 offset:6656
  ds_read_b64_tr_b16 v[96:97], v7 offset:7168
  ds_read_b64_tr_b16 v[100:101], v10 offset:7168
  ds_read_b64_tr_b16 v[98:99], v7 offset:8192
  ds_read_b64_tr_b16 v[102:103], v10 offset:8192
  ds_read_b64_tr_b16 v[104:105], v7 offset:9216
  ds_read_b64_tr_b16 v[108:109], v10 offset:9216
  ds_read_b64_tr_b16 v[106:107], v7 offset:10240
  ds_read_b64_tr_b16 v[110:111], v10 offset:10240
  ds_read_b64_tr_b16 v[112:113], v7 offset:10752
  ds_read_b64_tr_b16 v[116:117], v10 offset:10752
  ds_read_b64_tr_b16 v[114:115], v7 offset:11776
  ds_read_b64_tr_b16 v[118:119], v10 offset:11776
  ds_read_b64_tr_b16 v[120:121], v7 offset:12800
  ds_read_b64_tr_b16 v[124:125], v10 offset:12800
  ds_read_b64_tr_b16 v[122:123], v7 offset:13824
  ds_read_b64_tr_b16 v[126:127], v10 offset:13824
  ds_read_b64_tr_b16 v[128:129], v7 offset:14336
  ds_read_b64_tr_b16 v[132:133], v10 offset:14336
  ds_read_b64_tr_b16 v[130:131], v7 offset:15360
  ds_read_b64_tr_b16 v[134:135], v10 offset:15360
  ds_read_b64_tr_b16 v[136:137], v7 offset:16384
  ds_read_b64_tr_b16 v[140:141], v10 offset:16384
  ds_read_b64_tr_b16 v[138:139], v7 offset:17408
  ds_read_b64_tr_b16 v[142:143], v10 offset:17408
  ds_read_b64_tr_b16 v[144:145], v7 offset:17920
  ds_read_b64_tr_b16 v[148:149], v10 offset:17920
  ds_read_b64_tr_b16 v[146:147], v7 offset:18944
  ds_read_b64_tr_b16 v[150:151], v10 offset:18944
  ds_read_b64_tr_b16 v[152:153], v7 offset:19968
  ds_read_b64_tr_b16 v[156:157], v10 offset:19968
  ds_read_b64_tr_b16 v[154:155], v7 offset:20992
  ds_read_b64_tr_b16 v[158:159], v10 offset:20992
  ds_read_b64_tr_b16 v[160:161], v7 offset:21504
  ds_read_b64_tr_b16 v[164:165], v10 offset:21504
  ds_read_b64_tr_b16 v[162:163], v7 offset:22528
  ds_read_b64_tr_b16 v[166:167], v10 offset:22528
  ds_read_b64_tr_b16 v[168:169], v7 offset:23552
  ds_read_b64_tr_b16 v[172:173], v10 offset:23552
  ds_read_b64_tr_b16 v[170:171], v7 offset:24576
  ds_read_b64_tr_b16 v[174:175], v10 offset:24576
  ds_read_b64_tr_b16 v[176:177], v7 offset:25088
  ds_read_b64_tr_b16 v[180:181], v10 offset:25088
  ds_read_b64_tr_b16 v[178:179], v7 offset:26112
  ds_read_b64_tr_b16 v[182:183], v10 offset:26112
  ds_read_b64_tr_b16 v[184:185], v7 offset:27136
  ds_read_b64_tr_b16 v[188:189], v10 offset:27136
  ds_read_b64_tr_b16 v[186:187], v7 offset:28160
  ds_read_b64_tr_b16 v[190:191], v10 offset:28160
  v_cmp_gt_u32 vcc, 32, v1
  s_waitcnt lgkmcnt(0)
  s_nop 0
  v_cndmask_b32 v186, 0, v186, vcc
  v_cndmask_b32 v187, 0, v187, vcc
  v_cndmask_b32 v190, 0, v190, vcc
  v_cndmask_b32 v191, 0, v191, vcc
  s_mov_b32 s63, 65536
  s_branch L_poll11_i
L_poll11:
  s_sleep 1
L_poll11_i:
  buffer_load_dword v12, v6, s[32:35], 0 offen sc1
  s_sub_u32 s63, s63, 1
  s_cbranch_scc1 L_poll11_x
  s_waitcnt vmcnt(0)
  v_cmp_eq_u32 vcc, -1, v12
  s_cbranch_vccnz L_poll11
L_poll11_x:
  s_mov_b32 s63, 65536
  s_add_u32 s56, s55, 0
  buffer_load_dwordx4 v[192:195], v13, s[32:35], s56 offen offset:0 sc1
  buffer_load_dwordx4 v[196:199], v13, s[32:35], s56 offen offset:1024 sc1
  buffer_load_dwordx4 v[200:203], v13, s[32:35], s56 offen offset:2048 sc1
  buffer_load_dwordx4 v[204:207], v13, s[32:35], s56 offen offset:3072 sc1
  s_add_u32 s56, s55, 4096
  buffer_load_dwordx4 v[208:211], v13, s[32:35], s56 offen offset:0 sc1
  buffer_load_dwordx4 v[212:215], v13, s[32:35], s56 offen offset:1024 sc1
  buffer_load_dwordx4 v[216:219], v13, s[32:35], s56 offen offset:2048 sc1
  buffer_load_dwordx4 v[220:223], v13, s[32:35], s56 offen offset:3072 sc1
  s_add_u32 s56, s55, 8192
  buffer_load_dwordx4 v[224:227], v13, s[32:35], s56 offen offset:0 sc1
  buffer_load_dwordx4 v[228:231], v13, s[32:35], s56 offen offset:1024 sc1
  buffer_load_dwordx4 v[232:235], v13, s[32:35], s56 offen offset:2048 sc1
  buffer_load_dwordx4 v[236:239], v13, s[32:35], s56 offen offset:3072 sc1
  s_add_u32 s56, s55, 12288
  buffer_load_dwordx4 v[240:243], v13, s[32:35], s56 offen offset:0 sc1
  buffer_load_dwordx4 v[244:247], v13, s[32:35], s56 offen offset:1024 sc1
  buffer_load_dwordx4 v[248:251], v13, s[32:35], s56 offen offset:2048 sc1
  buffer_load_dwordx4 v[252:255], v13, s[32:35], s56 offen offset:3072 sc1
  s_xor_b32 s56, s28, 2
  s_mul_i32 s56, s56, 8704
  s_mul_i32 s57, s28, 8704
  s_mul_i32 s54, s58, 4352
  s_add_u32 s54, s54, 77824
  v_lshrrev_b32 v14, 3, v1
  v_and_b32 v15, 7, v1
  v_mul_u32_u24 v2, 1792, v14
  v_lshl_add_u32 v2, v15, 4, v2
  v_mul_u32_u24 v14, 272, v14
  v_lshl_add_u32 v14, v15, 5, v14
  v_add3_u32 v11, v14, s54, 0
  v_add_u32 v14, s57, v11
  v_add_u32 v11, s56, v11
  v_and_b32 v8, 31, v1
  v_mul_u32_u24 v8, 272, v8
  v_lshrrev_b32 v15, 5, v1
  v_lshl_add_u32 v8, v15, 4, v8
  s_add_u32 s57, s57, 77824
  s_lshl_b32 s54, s58, 7
  s_sub_u32 s56, s57, s54
  s_add_u32 s57, s57, s54
  v_add_u32 v15, s56, v8
  v_add_u32 v8, s57, v8
  s_lshl_b32 s53, s53, 1
  s_add_u32 s53, s53, s58
  s_mul_i32 s53, s53, 28672
  s_lshl_b32 s52, s52, 7
  s_add_u32 s52, s52, s53
  s_add_u32 s53, s52, 14336
L_oj:
  s_sub_u32 s63, s63, 1
  s_waitcnt vmcnt(15)
  v_mfma_f32_32x32x16_bf16 v[48:63], v[68:71], v[192:195], 0
  v_max_u32 v12, v192, v194
  v_mfma_f32_32x32x16_bf16 v[32:47], v[64:67], v[192:195], 0
  s_waitcnt vmcnt(14)
  v_mfma_f32_32x32x16_bf16 v[48:63], v[76:79], v[196:199], v[48:63]
  v_max3_u32 v12, v12, v196, v198
  v_mfma_f32_32x32x16_bf16 v[32:47], v[72:75], v[196:199], v[32:47]
  s_waitcnt vmcnt(13)
  v_mfma_f32_32x32x16_bf16 v[48:63], v[84:87], v[200:203], v[48:63]
  v_max3_u32 v12, v12, v200, v202
  v_mfma_f32_32x32x16_bf16 v[32:47], v[80:83], v[200:203], v[32:47]
  s_waitcnt vmcnt(12)
  v_mfma_f32_32x32x16_bf16 v[48:63], v[92:95], v[204:207], v[48:63]
  v_max3_u32 v12, v12, v204, v206
  v_mfma_f32_32x32x16_bf16 v[32:47], v[88:91], v[204:207], v[32:47]
  s_waitcnt vmcnt(11)
  v_mfma_f32_32x32x16_bf16 v[48:63], v[100:103], v[208:211], v[48:63]
  v_max3_u32 v12, v12, v208, v210
  v_mfma_f32_32x32x16_bf16 v[32:47], v[96:99], v[208:211], v[32:47]
  s_waitcnt vmcnt(10)
  v_mfma_f32_32x32x16_bf16 v[48:63], v[108:111], v[212:215], v[48:63]
  v_max3_u32 v12, v12, v212, v214
  v_mfma_f32_32x32x16_bf16 v[32:47], v[104:107], v[212:215], v[32:47]
  s_waitcnt vmcnt(9)
  v_mfma_f32_32x32x16_bf16 v[48:63], v[116:119], v[216:219], v[48:63]
  v_max3_u32 v12, v12, v216, v218
  v_mfma_f32_32x32x16_bf16 v[32:47], v[112:115], v[216:219], v[32:47]
  s_waitcnt vmcnt(8)
  v_mfma_f32_32x32x16_bf16 v[48:63], v[124:127], v[220:223], v[48:63]
  v_max3_u32 v12, v12, v220, v222
  v_mfma_f32_32x32x16_bf16 v[32:47], v[120:123], v[220:223], v[32:47]
  s_waitcnt vmcnt(7)
  v_mfma_f32_32x32x16_bf16 v[48:63], v[132:135], v[224:227], v[48:63]
  v_max3_u32 v12, v12, v224, v226
  v_mfma_f32_32x32x16_bf16 v[32:47], v[128:131], v[224:227], v[32:47]
  s_waitcnt vmcnt(6)
  v_mfma_f32_32x32x16_bf16 v[48:63], v[140:143], v[228:231], v[48:63]
  v_max3_u32 v12, v12, v228, v230
  v_mfma_f32_32x32x16_bf16 v[32:47], v[136:139], v[228:231], v[32:47]
  s_waitcnt vmcnt(5)
  v_mfma_f32_32x32x16_bf16 v[48:63], v[148:151], v[232:235], v[48:63]
  v_max3_u32 v12, v12, v232, v234
  v_mfma_f32_32x32x16_bf16 v[32:47], v[144:147], v[232:235], v[32:47]
  s_waitcnt vmcnt(4)
  v_mfma_f32_32x32x16_bf16 v[48:63], v[156:159], v[236:239], v[48:63]
  v_max3_u32 v12, v12, v236, v238
  v_mfma_f32_32x32x16_bf16 v[32:47], v[152:155], v[236:239], v[32:47]
  s_waitcnt vmcnt(3)
  v_mfma_f32_32x32x16_bf16 v[48:63], v[164:167], v[240:243], v[48:63]
  v_max3_u32 v12, v12, v240, v242
  v_mfma_f32_32x32x16_bf16 v[32:47], v[160:163], v[240:243], v[32:47]
  s_waitcnt vmcnt(2)
  v_mfma_f32_32x32x16_bf16 v[48:63], v[172:175], v[244:247], v[48:63]
  v_max3_u32 v12, v12, v244, v246
  v_mfma_f32_32x32x16_bf16 v[32:47], v[168:171], v[244:247], v[32:47]
  s_waitcnt vmcnt(1)
  v_mfma_f32_32x32x16_bf16 v[48:63], v[180:183], v[248:251], v[48:63]
  v_max3_u32 v12, v12, v248, v250
  v_mfma_f32_32x32x16_bf16 v[32:47], v[176:179], v[248:251], v[32:47]
  s_waitcnt vmcnt(0)
  v_mfma_f32_32x32x16_bf16 v[48:63], v[188:191], v[252:255], v[48:63]
  v_max3_u32 v12, v12, v252, v254
  v_cmp_eq_u32 vcc, -1, v12
  s_cmp_eq_u32 s63, 0
  s_cselect_b64 vcc, 0, vcc
  v_mov_b32 v9, 4
  v_mfma_f32_32x32x16_bf16 v[32:47], v[184:187], v[252:255], v[32:47]
  s_cbranch_vccnz L_og
  s_nop 4
  ds_write_b128 v15, v[48:51] offset:128
  ds_write_b128 v15, v[52:55] offset:160
  ds_write_b128 v15, v[56:59] offset:192
  ds_write_b128 v15, v[60:63] offset:224
  s_nop 1
  ds_write_b128 v8, v[32:35] offset:0
  ds_write_b128 v8, v[36:39] offset:32
  ds_write_b128 v8, v[40:43] offset:64
  ds_write_b128 v8, v[44:47] offset:96
  ds_write_b32 v17, v9 offset:512
  ds_read_b128 v[32:35], v14 offset:0
  ds_read_b128 v[36:39], v14 offset:16
  ds_read_b128 v[40:43], v14 offset:2176
  ds_read_b128 v[44:47], v14 offset:2192
  s_mov_b32 s63, 65536
L_ls12:
  ds_read_b32 v12, v18 offset:512
  s_sub_u32 s63, s63, 1
  s_cbranch_scc1 L_ls12_x
  s_waitcnt lgkmcnt(0)
  v_cmp_gt_u32 vcc, 4, v12
  s_cbranch_vccnz L_ls12
L_ls12_x:
  ds_read_b128 v[48:51], v11 offset:0
  ds_read_b128 v[52:55], v11 offset:16
  ds_read_b128 v[56:59], v11 offset:2176
  ds_read_b128 v[60:63], v11 offset:2192
  s_or_b32 s56, s2, s28
  s_cmp_eq_u32 s56, 0
  s_cselect_b32 s56, 0, 1073741824
  v_mov_b32 v6, s56
  buffer_store_dword v3, v6, s[32:35], 0 offen sc1
  s_waitcnt lgkmcnt(3)
  v_pk_add_f32 v[32:33], v[32:33], v[48:49]
  v_pk_add_f32 v[34:35], v[34:35], v[50:51]
  v_cvt_pk_bf16_f32 v20, v32, v33
  v_cvt_pk_bf16_f32 v21, v34, v35
  s_waitcnt lgkmcnt(2)
  v_pk_add_f32 v[36:37], v[36:37], v[52:53]
  v_pk_add_f32 v[38:39], v[38:39], v[54:55]
  v_cvt_pk_bf16_f32 v22, v36, v37
  v_cvt_pk_bf16_f32 v23, v38, v39
  buffer_store_dwordx4 v[20:23], v2, s[36:39], s52 offen sc1
  s_waitcnt lgkmcnt(1)
  v_pk_add_f32 v[40:41], v[40:41], v[56:57]
  v_pk_add_f32 v[42:43], v[42:43], v[58:59]
  v_cvt_pk_bf16_f32 v24, v40, v41
  v_cvt_pk_bf16_f32 v25, v42, v43
  s_waitcnt lgkmcnt(0)
  v_pk_add_f32 v[44:45], v[44:45], v[60:61]
  v_pk_add_f32 v[46:47], v[46:47], v[62:63]
  v_cvt_pk_bf16_f32 v26, v44, v45
  v_cvt_pk_bf16_f32 v27, v46, v47
  buffer_store_dwordx4 v[24:27], v2, s[36:39], s53 offen sc1
  s_endpgm
L_og:
  s_add_u32 s56, s55, 0
  buffer_load_dwordx4 v[192:195], v13, s[32:35], s56 offen offset:0 sc1
  buffer_load_dwordx4 v[196:199], v13, s[32:35], s56 offen offset:1024 sc1
  buffer_load_dwordx4 v[200:203], v13, s[32:35], s56 offen offset:2048 sc1
  buffer_load_dwordx4 v[204:207], v13, s[32:35], s56 offen offset:3072 sc1
  s_add_u32 s56, s55, 4096
  buffer_load_dwordx4 v[208:211], v13, s[32:35], s56 offen offset:0 sc1
  buffer_load_dwordx4 v[212:215], v13, s[32:35], s56 offen offset:1024 sc1
  buffer_load_dwordx4 v[216:219], v13, s[32:35], s56 offen offset:2048 sc1
  buffer_load_dwordx4 v[220:223], v13, s[32:35], s56 offen offset:3072 sc1
  s_add_u32 s56, s55, 8192
  buffer_load_dwordx4 v[224:227], v13, s[32:35], s56 offen offset:0 sc1
  buffer_load_dwordx4 v[228:231], v13, s[32:35], s56 offen offset:1024 sc1
  buffer_load_dwordx4 v[232:235], v13, s[32:35], s56 offen offset:2048 sc1
  buffer_load_dwordx4 v[236:239], v13, s[32:35], s56 offen offset:3072 sc1
  s_add_u32 s56, s55, 12288
  buffer_load_dwordx4 v[240:243], v13, s[32:35], s56 offen offset:0 sc1
  buffer_load_dwordx4 v[244:247], v13, s[32:35], s56 offen offset:1024 sc1
  buffer_load_dwordx4 v[248:251], v13, s[32:35], s56 offen offset:2048 sc1
  buffer_load_dwordx4 v[252:255], v13, s[32:35], s56 offen offset:3072 sc1
  s_branch L_oj
.p2align 6
L_A:
  s_setprio 3
  s_mov_b32 s3, s53
  v_lshrrev_b32 v176, 2, v1
  v_and_b32 v177, 3, v1
  s_and_b32 s59, s2, 31
  s_lshl_b32 s59, s59, 1
  s_and_b32 s56, s28, 1
  s_add_u32 s59, s59, s56
  s_lshr_b32 s60, s2, 5
  s_lshl_b32 s60, s60, 1
  s_lshr_b32 s56, s28, 1
  s_add_u32 s60, s60, s56
  s_mul_i32 s61, s59, 28672
  s_lshl_b32 s56, s60, 6
  s_add_u32 s61, s61, s56
  v_mul_u32_u24 v178, 1792, v176
  v_lshl_add_u32 v178, v177, 4, v178
  v_add_u32 v178, s61, v178
  s_mul_i32 s54, s28, 2176
  s_add_u32 s54, s54, 149760
  v_subrev_u32 v187, 2688, v178
  v_subrev_u32 v188, 1792, v178
  v_subrev_u32 v189, 896, v178
  s_lshl_b32 s56, s60, 8
  v_lshl_add_u32 v186, v1, 2, s56
  s_mov_b32 m0, s54
  s_mov_b32 s38, 1835008
  s_cmp_lt_u32 s2, 224
  s_mov_b32 s36, s12
  s_mov_b32 s37, s13
  s_cbranch_scc0 L_nold
  global_load_lds_dword v186, s[16:17]
  buffer_load_dwordx4 v[32:35], v187, s[36:39], 0 offen
  buffer_load_dwordx4 v[36:39], v188, s[36:39], 0 offen
  buffer_load_dwordx4 v[40:43], v189, s[36:39], 0 offen
  buffer_load_dwordx4 v[44:47], v178, s[36:39], 0 offen offset:0
  buffer_load_dwordx4 v[48:51], v178, s[36:39], 0 offen offset:896
  global_load_dwordx4 v[52:55], v178, s[14:15] offset:0
  global_load_dwordx4 v[56:59], v178, s[14:15] offset:896
L_nold:
  s_lshl_b32 s55, s30, 2
  s_add_u32 s55, s55, s28
  s_lshl_b32 s55, s55, 4
  s_add_u32 s55, s55, s29
  s_lshl_b32 s55, s55, 11
  s_add_u32 s55, s55, 6291456
  s_lshl_b32 s56, s28, 12
  s_add_u32 s56, s56, 57344
  v_and_b32 v12, 31, v1
  v_lshrrev_b32 v13, 5, v1
  v_bfe_u32 v14, v1, 1, 3
  v_xor_b32 v14, v14, v13
  v_lshlrev_b32 v14, 4, v14
  v_lshl_add_u32 v14, v12, 7, v14
  v_add_u32 v6, s56, v14
  v_xor_b32 v7, 32, v6
  v_xor_b32 v8, 64, v6
  v_xor_b32 v9, 96, v6
  s_mov_b32 s32, s26
  s_mov_b32 s33, s27
  v_bfe_u32 v14, v1, 2, 2
  v_lshl_add_u32 v14, v13, 3, v14
  v_bfe_u32 v11, v1, 4, 1
  v_bfrev_b32 v10, v177
  v_lshrrev_b32 v10, 27, v10
  v_lshlrev_b32 v15, 3, v177
  s_bitcmp1_b32 s2, 0
  s_cselect_b64 vcc, -1, 0
  v_cndmask_b32 v15, v10, v15, vcc
  v_lshl_add_u32 v15, v11, 5, v15
  v_lshl_add_u32 v10, v11, 5, v10
  v_lshl_add_u32 v10, v14, 6, v10
  v_lshl_add_u32 v15, v14, 7, v15
  v_bfe_u32 v11, v1, 3, 1
  v_lshl_add_u32 v11, v11, 6, v15
  v_xor_b32 v15, 64, v11
  v_mul_u32_u24 v246, 7168, v13
  v_lshl_add_u32 v246, v12, 4, v246
  s_lshl_b32 s56, s28, 4
  s_add_u32 s56, s56, s30
  s_lshl_b32 s56, s56, 9
  s_add_u32 s56, s56, s62
  s_lshl_b32 s56, s56, 7
  s_add_u32 s56, s56, 1110016
  v_lshl_add_u32 v242, v12, 2, s56
  v_mov_b32 v12, 1073741824
  v_cndmask_b32 v242, v12, v242, vcc
  v_mov_b32 v12, 0x3f803f80
  v_lshlrev_b32 v13, 4, v1
  s_lshl_b32 s56, s28, 2
  s_add_u32 s56, s56, 158464
  v_add_u32 v243, s56, v13
  s_mov_b32 s56, 158464
  v_lshl_add_u32 v244, v1, 2, s56
  v_add_u32 v241, 1024, v244
  v_mul_u32_u24 v5, 2688, v176
  v_lshl_add_u32 v5, v177, 4, v5
  s_mul_i32 s56, s29, 56
  s_and_b32 s56, s56, 0xfff0
  s_mul_i32 s57, s28, 43008
  s_add_u32 s56, s56, s57
  v_add_u32 v5, s56, v5
  s_mov_b32 s40, s6
  s_mov_b32 s41, s7
  s_mov_b32 s42, 1204224
  s_mov_b32 s43, 0x20000
  v_add_u32 v160, 0x10000, v6
  v_mov_b32 v248, -1
  v_add_u32 v161, 0x10000, v7
  v_mov_b32 v249, -1
  v_add_u32 v162, 0x10000, v8
  v_mov_b32 v250, -1
  v_add_u32 v163, 0x10000, v9
  v_mov_b32 v251, -1
  v_lshrrev_b32 v179, 5, v1
  v_mul_u32_u24 v179, 544, v179
  v_bfe_u32 v183, v1, 2, 3
  v_lshl_add_u32 v179, v183, 6, v179
  v_lshl_add_u32 v179, v177, 4, v179
  v_add_u32 v179, s54, v179
  v_lshrrev_b32 v183, 3, v1
  v_lshlrev_b32 v183, 13, v183
  v_and_b32 v184, 7, v1
  v_lshl_add_u32 v183, v184, 4, v183
  s_lshl_b32 s56, s60, 17
  s_lshl_b32 s61, s59, 7
  s_add_u32 s56, s56, s61
  v_add_u32 v183, s56, v183
  s_mov_b32 s61, 0xffff0000
  v_mul_u32_u24 v185, 544, v177
  v_xor_b32 v184, 3, v176
  v_lshl_add_u32 v185, v184, 2, v185
  v_add_u32 v185, s54, v185
  v_lshl_add_u32 v184, v177, 6, s54
  s_lshl_b32 s56, s60, 6
  s_add_u32 s56, s56, s59
  s_lshl_b32 s56, s56, 7
  s_add_u32 s56, s56, 262144
  v_lshl_add_u32 v2, v1, 2, s56
  v_lshrrev_b32 v255, 5, v1
  v_lshl_or_b32 v2, v255, 30, v2
  s_waitcnt lgkmcnt(0)
  s_add_u32 s31, s31, 0x9e3779b9
  v_mov_b32 v3, s31
  s_cmp_lt_u32 s2, 224
  s_cbranch_scc0 L_nopre
  s_waitcnt vmcnt(7)
  ds_read_b128 v[104:107], v184 offset:0
  ds_read_b128 v[108:111], v184 offset:16
  ds_read_b128 v[112:115], v184 offset:32
  ds_read_b128 v[116:119], v184 offset:48
  s_waitcnt lgkmcnt(0)
  v_lshlrev_b32 v72, 16, v104
  v_and_b32 v80, s61, v104
  v_lshlrev_b32 v88, 16, v105
  v_and_b32 v96, s61, v105
  v_lshlrev_b32 v73, 16, v106
  v_and_b32 v81, s61, v106
  v_lshlrev_b32 v89, 16, v107
  v_and_b32 v97, s61, v107
  v_lshlrev_b32 v74, 16, v108
  v_and_b32 v82, s61, v108
  v_lshlrev_b32 v90, 16, v109
  v_and_b32 v98, s61, v109
  v_lshlrev_b32 v75, 16, v110
  v_and_b32 v83, s61, v110
  v_lshlrev_b32 v91, 16, v111
  v_and_b32 v99, s61, v111
  v_lshlrev_b32 v76, 16, v112
  v_and_b32 v84, s61, v112
  v_lshlrev_b32 v92, 16, v113
  v_and_b32 v100, s61, v113
  v_lshlrev_b32 v77, 16, v114
  v_and_b32 v85, s61, v114
  v_lshlrev_b32 v93, 16, v115
  v_and_b32 v101, s61, v115
  v_lshlrev_b32 v78, 16, v116
  v_and_b32 v86, s61, v116
  v_lshlrev_b32 v94, 16, v117
  v_and_b32 v102, s61, v117
  v_lshlrev_b32 v79, 16, v118
  v_and_b32 v87, s61, v118
  v_lshlrev_b32 v95, 16, v119
  v_and_b32 v103, s61, v119
  s_waitcnt vmcnt(2)
  v_lshlrev_b32 v104, 16, v32
  v_and_b32 v105, s61, v32
  v_lshlrev_b32 v106, 16, v33
  v_and_b32 v107, s61, v33
  v_lshlrev_b32 v108, 16, v34
  v_and_b32 v109, s61, v34
  v_lshlrev_b32 v110, 16, v35
  v_and_b32 v111, s61, v35
  v_lshlrev_b32 v112, 16, v36
  v_and_b32 v113, s61, v36
  v_lshlrev_b32 v114, 16, v37
  v_and_b32 v115, s61, v37
  v_lshlrev_b32 v116, 16, v38
  v_and_b32 v117, s61, v38
  v_lshlrev_b32 v118, 16, v39
  v_and_b32 v119, s61, v39
  v_lshlrev_b32 v120, 16, v40
  v_and_b32 v121, s61, v40
  v_lshlrev_b32 v122, 16, v41
  v_and_b32 v123, s61, v41
  v_lshlrev_b32 v124, 16, v42
  v_and_b32 v125, s61, v42
  v_lshlrev_b32 v126, 16, v43
  v_and_b32 v127, s61, v43
  v_lshlrev_b32 v128, 16, v44
  v_and_b32 v129, s61, v44
  v_lshlrev_b32 v130, 16, v45
  v_and_b32 v131, s61, v45
  v_lshlrev_b32 v132, 16, v46
  v_and_b32 v133, s61, v46
  v_lshlrev_b32 v134, 16, v47
  v_and_b32 v135, s61, v47
  v_lshlrev_b32 v136, 16, v48
  v_and_b32 v137, s61, v48
  v_lshlrev_b32 v138, 16, v49
  v_and_b32 v139, s61, v49
  v_lshlrev_b32 v140, 16, v50
  v_and_b32 v141, s61, v50
  v_lshlrev_b32 v142, 16, v51
  v_and_b32 v143, s61, v51
  v_pk_mul_f32 v[144:145], v[104:105], v[96:97]
  v_pk_fma_f32 v[144:145], v[112:113], v[88:89], v[144:145]
  v_pk_fma_f32 v[144:145], v[120:121], v[80:81], v[144:145]
  v_pk_fma_f32 v[144:145], v[128:129], v[72:73], v[144:145]
  v_pk_mul_f32 v[146:147], v[106:107], v[98:99]
  v_pk_fma_f32 v[146:147], v[114:115], v[90:91], v[146:147]
  v_pk_fma_f32 v[146:147], v[122:123], v[82:83], v[146:147]
  v_pk_fma_f32 v[146:147], v[130:131], v[74:75], v[146:147]
  v_pk_mul_f32 v[148:149], v[108:109], v[100:101]
  v_pk_fma_f32 v[148:149], v[116:117], v[92:93], v[148:149]
  v_pk_fma_f32 v[148:149], v[124:125], v[84:85], v[148:149]
  v_pk_fma_f32 v[148:149], v[132:133], v[76:77], v[148:149]
  v_pk_mul_f32 v[150:151], v[110:111], v[102:103]
  v_pk_fma_f32 v[150:151], v[118:119], v[94:95], v[150:151]
  v_pk_fma_f32 v[150:151], v[126:127], v[86:87], v[150:151]
  v_pk_fma_f32 v[150:151], v[134:135], v[78:79], v[150:151]
  v_pk_mul_f32 v[152:153], v[112:113], v[96:97]
  v_pk_fma_f32 v[152:153], v[120:121], v[88:89], v[152:153]
  v_pk_fma_f32 v[152:153], v[128:129], v[80:81], v[152:153]
  v_pk_fma_f32 v[152:153], v[136:137], v[72:73], v[152:153]
  v_pk_mul_f32 v[154:155], v[114:115], v[98:99]
  v_pk_fma_f32 v[154:155], v[122:123], v[90:91], v[154:155]
  v_pk_fma_f32 v[154:155], v[130:131], v[82:83], v[154:155]
  v_pk_fma_f32 v[154:155], v[138:139], v[74:75], v[154:155]
  v_pk_mul_f32 v[156:157], v[116:117], v[100:101]
  v_pk_fma_f32 v[156:157], v[124:125], v[92:93], v[156:157]
  v_pk_fma_f32 v[156:157], v[132:133], v[84:85], v[156:157]
  v_pk_fma_f32 v[156:157], v[140:141], v[76:77], v[156:157]
  v_pk_mul_f32 v[158:159], v[118:119], v[102:103]
  v_pk_fma_f32 v[158:159], v[126:127], v[94:95], v[158:159]
  v_pk_fma_f32 v[158:159], v[134:135], v[86:87], v[158:159]
  v_pk_fma_f32 v[158:159], v[142:143], v[78:79], v[158:159]
  s_waitcnt vmcnt(0)
  v_lshlrev_b32 v192, 16, v52
  v_and_b32 v193, s61, v52
  v_lshlrev_b32 v194, 16, v53
  v_and_b32 v195, s61, v53
  v_lshlrev_b32 v196, 16, v54
  v_and_b32 v197, s61, v54
  v_lshlrev_b32 v198, 16, v55
  v_and_b32 v199, s61, v55
  v_lshlrev_b32 v200, 16, v56
  v_and_b32 v201, s61, v56
  v_lshlrev_b32 v202, 16, v57
  v_and_b32 v203, s61, v57
  v_lshlrev_b32 v204, 16, v58
  v_and_b32 v205, s61, v58
  v_lshlrev_b32 v206, 16, v59
  v_and_b32 v207, s61, v59
  v_pk_mul_f32 v[144:145], v[144:145], v[192:193]
  v_pk_mul_f32 v[146:147], v[146:147], v[194:195]
  v_pk_mul_f32 v[148:149], v[148:149], v[196:197]
  v_pk_mul_f32 v[150:151], v[150:151], v[198:199]
  v_pk_mul_f32 v[152:153], v[152:153], v[200:201]
  v_pk_mul_f32 v[154:155], v[154:155], v[202:203]
  v_pk_mul_f32 v[156:157], v[156:157], v[204:205]
  v_pk_mul_f32 v[158:159], v[158:159], v[206:207]
  v_cvt_pk_bf16_f32 v20, v152, v144
  v_cvt_pk_bf16_f32 v21, v153, v145
  v_cvt_pk_bf16_f32 v22, v154, v146
  v_cvt_pk_bf16_f32 v23, v155, v147
  v_cvt_pk_bf16_f32 v24, v156, v148
  v_cvt_pk_bf16_f32 v25, v157, v149
  v_cvt_pk_bf16_f32 v26, v158, v150
  v_cvt_pk_bf16_f32 v27, v159, v151
  ds_write_b32 v185, v20 offset:0
  ds_write_b32 v185, v21 offset:64
  ds_write_b32 v185, v22 offset:128
  ds_write_b32 v185, v23 offset:192
  ds_write_b32 v185, v24 offset:256
  ds_write_b32 v185, v25 offset:320
  ds_write_b32 v185, v26 offset:384
  ds_write_b32 v185, v27 offset:448
  ds_read_b128 v[168:171], v179 offset:0
  ds_read_b128 v[172:175], v179 offset:1088
  s_mov_b32 s56, 8388608
  s_mov_b32 s57, 8454144
  s_waitcnt lgkmcnt(1)
  buffer_store_dwordx4 v[168:171], v183, s[32:35], s56 offen sc1
  s_waitcnt lgkmcnt(0)
  buffer_store_dwordx4 v[172:175], v183, s[32:35], s57 offen sc1
L_nopre:
  s_mov_b32 s58, 0x0fffffff
  s_mov_b32 s59, s58
  s_mov_b32 s60, -1
  s_mov_b32 s61, 0
  s_waitcnt vmcnt(0)
  buffer_store_dword v3, v2, s[32:35], 0 offen sc1
  s_mov_b32 s63, 65536
L_ls13:
  s_sleep 1
  ds_read_b32 v14, v241
  s_sub_u32 s63, s63, 1
  s_cbranch_scc1 L_ls13_x
  s_waitcnt lgkmcnt(0)
  v_cmp_gt_u32 vcc, 1, v14
  s_cbranch_vccnz L_ls13
L_ls13_x:
  ds_read_b128 v[16:19], v6 offset:0
  ds_read_b64_tr_b16 v[208:209], v11 offset:0
  ds_read_b64_tr_b16 v[210:211], v11 offset:512
  ds_read_b64_tr_b16 v[212:213], v15 offset:0
  ds_read_b64_tr_b16 v[214:215], v15 offset:512
  ds_read_b128 v[20:23], v7 offset:0
  ds_read_b64_tr_b16 v[216:217], v11 offset:2048
  ds_read_b64_tr_b16 v[218:219], v11 offset:2560
  ds_read_b64_tr_b16 v[220:221], v15 offset:2048
  ds_read_b64_tr_b16 v[222:223], v15 offset:2560
  s_bitcmp1_b32 s2, 0
  s_cbranch_scc1 L_gv
  s_waitcnt lgkmcnt(5)
  v_mfma_f32_32x32x16_bf16 v[128:143], v[208:211], v[16:19], 0
  ds_read_b128 v[24:27], v8 offset:0
  ds_read_b64_tr_b16 v[224:225], v11 offset:4096
  v_mfma_f32_32x32x16_bf16 v[144:159], v[212:215], v[16:19], 0
  ds_read_b64_tr_b16 v[226:227], v11 offset:4608
  ds_read_b64_tr_b16 v[228:229], v15 offset:4096
  ds_read_b64_tr_b16 v[230:231], v15 offset:4608
  s_waitcnt lgkmcnt(5)
  v_mfma_f32_32x32x16_bf16 v[128:143], v[216:219], v[20:23], v[128:143]
  ds_read_b32 v14, v241
  ds_read_b128 v[28:31], v9 offset:0
  ds_read_b64_tr_b16 v[232:233], v11 offset:6144
  v_mfma_f32_32x32x16_bf16 v[144:159], v[220:223], v[20:23], v[144:159]
  ds_read_b64_tr_b16 v[234:235], v11 offset:6656
  ds_read_b64_tr_b16 v[236:237], v15 offset:6144
  ds_read_b64_tr_b16 v[238:239], v15 offset:6656
  v_mov_b32 v245, 1
  ds_write_b32 v243, v245
  s_waitcnt lgkmcnt(7)
  v_mfma_f32_32x32x16_bf16 v[128:143], v[224:227], v[24:27], v[128:143]
  s_waitcnt lgkmcnt(6)
  v_cmp_gt_u32 vcc, 2, v14
  s_cbranch_vccnz L_ls14_o
L_ls14:
  ds_read_b128 v[32:35], v6 offset:16384
  ds_read_b64_tr_b16 v[208:209], v11 offset:8192
  v_mfma_f32_32x32x16_bf16 v[144:159], v[228:231], v[24:27], v[144:159]
  ds_read_b64_tr_b16 v[210:211], v11 offset:8704
  ds_read_b64_tr_b16 v[212:213], v15 offset:8192
  ds_read_b64_tr_b16 v[214:215], v15 offset:8704
  s_waitcnt lgkmcnt(6)
  v_mfma_f32_32x32x16_bf16 v[128:143], v[232:235], v[28:31], v[128:143]
  ds_read_b128 v[36:39], v7 offset:16384
  ds_read_b64_tr_b16 v[216:217], v11 offset:10240
  v_mfma_f32_32x32x16_bf16 v[144:159], v[236:239], v[28:31], v[144:159]
  ds_read_b64_tr_b16 v[218:219], v11 offset:10752
  ds_read_b64_tr_b16 v[220:221], v15 offset:10240
  ds_read_b64_tr_b16 v[222:223], v15 offset:10752
  s_waitcnt lgkmcnt(5)
  v_mfma_f32_32x32x16_bf16 v[128:143], v[208:211], v[32:35], v[128:143]
  ds_read_b128 v[40:43], v8 offset:16384
  ds_read_b64_tr_b16 v[224:225], v11 offset:12288
  v_mfma_f32_32x32x16_bf16 v[144:159], v[212:215], v[32:35], v[144:159]
  ds_read_b64_tr_b16 v[226:227], v11 offset:12800
  ds_read_b64_tr_b16 v[228:229], v15 offset:12288
  ds_read_b64_tr_b16 v[230:231], v15 offset:12800
  s_waitcnt lgkmcnt(5)
  v_mfma_f32_32x32x16_bf16 v[128:143], v[216:219], v[36:39], v[128:143]
  ds_read_b32 v14, v241
  ds_read_b128 v[44:47], v9 offset:16384
  ds_read_b64_tr_b16 v[232:233], v11 offset:14336
  v_mfma_f32_32x32x16_bf16 v[144:159], v[220:223], v[36:39], v[144:159]
  ds_read_b64_tr_b16 v[234:235], v11 offset:14848
  ds_read_b64_tr_b16 v[236:237], v15 offset:14336
  ds_read_b64_tr_b16 v[238:239], v15 offset:14848
  v_mov_b32 v245, 2
  ds_write_b32 v243, v245
  s_waitcnt lgkmcnt(7)
  v_mfma_f32_32x32x16_bf16 v[128:143], v[224:227], v[40:43], v[128:143]
  s_waitcnt lgkmcnt(6)
  v_cmp_gt_u32 vcc, 3, v14
  s_cbranch_vccnz L_ls15_o
L_ls15:
  ds_read_b128 v[48:51], v6 offset:32768
  ds_read_b64_tr_b16 v[208:209], v11 offset:16384
  v_mfma_f32_32x32x16_bf16 v[144:159], v[228:231], v[40:43], v[144:159]
  ds_read_b64_tr_b16 v[210:211], v11 offset:16896
  ds_read_b64_tr_b16 v[212:213], v15 offset:16384
  ds_read_b64_tr_b16 v[214:215], v15 offset:16896
  s_waitcnt lgkmcnt(6)
  v_mfma_f32_32x32x16_bf16 v[128:143], v[232:235], v[44:47], v[128:143]
  ds_read_b128 v[52:55], v7 offset:32768
  ds_read_b64_tr_b16 v[216:217], v11 offset:18432
  v_mfma_f32_32x32x16_bf16 v[144:159], v[236:239], v[44:47], v[144:159]
  ds_read_b64_tr_b16 v[218:219], v11 offset:18944
  ds_read_b64_tr_b16 v[220:221], v15 offset:18432
  ds_read_b64_tr_b16 v[222:223], v15 offset:18944
  s_waitcnt lgkmcnt(5)
  v_mfma_f32_32x32x16_bf16 v[128:143], v[208:211], v[48:51], v[128:143]
  ds_read_b128 v[56:59], v8 offset:32768
  ds_read_b64_tr_b16 v[224:225], v11 offset:20480
  v_mfma_f32_32x32x16_bf16 v[144:159], v[212:215], v[48:51], v[144:159]
  ds_read_b64_tr_b16 v[226:227], v11 offset:20992
  ds_read_b64_tr_b16 v[228:229], v15 offset:20480
  ds_read_b64_tr_b16 v[230:231], v15 offset:20992
  s_waitcnt lgkmcnt(5)
  v_mfma_f32_32x32x16_bf16 v[128:143], v[216:219], v[52:55], v[128:143]
  ds_read_b32 v14, v241
  ds_read_b128 v[60:63], v9 offset:32768
  ds_read_b64_tr_b16 v[232:233], v11 offset:22528
  v_mfma_f32_32x32x16_bf16 v[144:159], v[220:223], v[52:55], v[144:159]
  ds_read_b64_tr_b16 v[234:235], v11 offset:23040
  ds_read_b64_tr_b16 v[236:237], v15 offset:22528
  ds_read_b64_tr_b16 v[238:239], v15 offset:23040
  v_mov_b32 v245, 3
  ds_write_b32 v243, v245
  s_waitcnt lgkmcnt(7)
  v_mfma_f32_32x32x16_bf16 v[128:143], v[224:227], v[56:59], v[128:143]
  s_waitcnt lgkmcnt(6)
  v_cmp_gt_u32 vcc, 4, v14
  s_cbranch_vccnz L_ls16_o
L_ls16:
  ds_read_b128 v[64:67], v6 offset:49152
  ds_read_b64_tr_b16 v[208:209], v11 offset:24576
  v_mfma_f32_32x32x16_bf16 v[144:159], v[228:231], v[56:59], v[144:159]
  ds_read_b64_tr_b16 v[210:211], v11 offset:25088
  ds_read_b64_tr_b16 v[212:213], v15 offset:24576
  ds_read_b64_tr_b16 v[214:215], v15 offset:25088
  s_waitcnt lgkmcnt(6)
  v_mfma_f32_32x32x16_bf16 v[128:143], v[232:235], v[60:63], v[128:143]
  ds_read_b128 v[68:71], v7 offset:49152
  ds_read_b64_tr_b16 v[216:217], v11 offset:26624
  v_mfma_f32_32x32x16_bf16 v[144:159], v[236:239], v[60:63], v[144:159]
  ds_read_b64_tr_b16 v[218:219], v11 offset:27136
  ds_read_b64_tr_b16 v[220:221], v15 offset:26624
  ds_read_b64_tr_b16 v[222:223], v15 offset:27136
  buffer_store_dword v12, v242, s[32:35], 0 offen sc1
  buffer_store_dwordx4 v[248:251], v13, s[32:35], s55 offen offset:0 sc1
  buffer_store_dwordx4 v[248:251], v13, s[32:35], s55 offen offset:1024 sc1
  s_waitcnt lgkmcnt(5)
  v_mfma_f32_32x32x16_bf16 v[128:143], v[208:211], v[64:67], v[128:143]
  ds_read_b128 v[72:75], v8 offset:49152
  ds_read_b64_tr_b16 v[224:225], v11 offset:28672
  v_mfma_f32_32x32x16_bf16 v[144:159], v[212:215], v[64:67], v[144:159]
  ds_read_b64_tr_b16 v[226:227], v11 offset:29184
  ds_read_b64_tr_b16 v[228:229], v15 offset:28672
  ds_read_b64_tr_b16 v[230:231], v15 offset:29184
  s_waitcnt lgkmcnt(5)
  v_mfma_f32_32x32x16_bf16 v[128:143], v[216:219], v[68:71], v[128:143]
  ds_read_b32 v14, v241
  ds_read_b128 v[76:79], v9 offset:49152
  ds_read_b64_tr_b16 v[232:233], v11 offset:30720
  v_mfma_f32_32x32x16_bf16 v[144:159], v[220:223], v[68:71], v[144:159]
  ds_read_b64_tr_b16 v[234:235], v11 offset:31232
  ds_read_b64_tr_b16 v[236:237], v15 offset:30720
  ds_read_b64_tr_b16 v[238:239], v15 offset:31232
  v_mov_b32 v245, 4
  ds_write_b32 v243, v245
  s_waitcnt lgkmcnt(7)
  v_mfma_f32_32x32x16_bf16 v[128:143], v[224:227], v[72:75], v[128:143]
  s_waitcnt lgkmcnt(6)
  v_cmp_gt_u32 vcc, 5, v14
  s_cbranch_vccnz L_ls17_o
L_ls17:
  ds_read_b128 v[80:83], v160 offset:0
  ds_read_b64_tr_b16 v[208:209], v11 offset:32768
  v_mfma_f32_32x32x16_bf16 v[144:159], v[228:231], v[72:75], v[144:159]
  ds_read_b64_tr_b16 v[210:211], v11 offset:33280
  ds_read_b64_tr_b16 v[212:213], v15 offset:32768
  ds_read_b64_tr_b16 v[214:215], v15 offset:33280
  ds_read_b32 v4, v244
  s_waitcnt lgkmcnt(7)
  v_mfma_f32_32x32x16_bf16 v[128:143], v[232:235], v[76:79], v[128:143]
  ds_read_b128 v[84:87], v161 offset:0
  ds_read_b64_tr_b16 v[216:217], v11 offset:34816
  v_mfma_f32_32x32x16_bf16 v[144:159], v[236:239], v[76:79], v[144:159]
  ds_read_b64_tr_b16 v[218:219], v11 offset:35328
  ds_read_b64_tr_b16 v[220:221], v15 offset:34816
  ds_read_b64_tr_b16 v[222:223], v15 offset:35328
  s_waitcnt lgkmcnt(6)
  v_mfma_f32_32x32x16_bf16 v[128:143], v[208:211], v[80:83], v[128:143]
  ds_read_b128 v[88:91], v162 offset:0
  ds_read_b64_tr_b16 v[224:225], v11 offset:36864
  v_mfma_f32_32x32x16_bf16 v[144:159], v[212:215], v[80:83], v[144:159]
  ds_read_b64_tr_b16 v[226:227], v11 offset:37376
  ds_read_b64_tr_b16 v[228:229], v15 offset:36864
  ds_read_b64_tr_b16 v[230:231], v15 offset:37376
  s_waitcnt lgkmcnt(10)
  v_cmp_gt_u32 vcc, 4, v4
  s_lshl_b32 s57, s28, 10
  s_cbranch_vccnz L_ls18_o
L_ls18:
  s_add_u32 m0, s57, 0
  s_mul_i32 s56, s3, 172032
  buffer_load_dwordx4 v5, s[40:43], s56 offen lds
  s_add_u32 s3, s3, 1
  s_cmp_eq_u32 s3, 7
  s_cselect_b32 s3, 0, s3
  s_add_u32 m0, s57, 4096
  s_mul_i32 s56, s3, 172032
  buffer_load_dwordx4 v5, s[40:43], s56 offen lds
  s_add_u32 s3, s3, 1
  s_cmp_eq_u32 s3, 7
  s_cselect_b32 s3, 0, s3
  s_waitcnt lgkmcnt(5)
  v_mfma_f32_32x32x16_bf16 v[128:143], v[216:219], v[84:87], v[128:143]
  ds_read_b32 v14, v241
  ds_read_b128 v[92:95], v163 offset:0
  ds_read_b64_tr_b16 v[232:233], v11 offset:38912
  v_mfma_f32_32x32x16_bf16 v[144:159], v[220:223], v[84:87], v[144:159]
  ds_read_b64_tr_b16 v[234:235], v11 offset:39424
  ds_read_b64_tr_b16 v[236:237], v15 offset:38912
  ds_read_b64_tr_b16 v[238:239], v15 offset:39424
  v_mov_b32 v245, 5
  ds_write_b32 v243, v245
  s_add_u32 m0, s57, 8192
  s_mul_i32 s56, s3, 172032
  buffer_load_dwordx4 v5, s[40:43], s56 offen lds
  s_add_u32 s3, s3, 1
  s_cmp_eq_u32 s3, 7
  s_cselect_b32 s3, 0, s3
  s_add_u32 m0, s57, 12288
  s_mul_i32 s56, s3, 172032
  buffer_load_dwordx4 v5, s[40:43], s56 offen lds
  s_add_u32 s3, s3, 1
  s_cmp_eq_u32 s3, 7
  s_cselect_b32 s3, 0, s3
  s_waitcnt lgkmcnt(7)
  v_mfma_f32_32x32x16_bf16 v[128:143], v[224:227], v[88:91], v[128:143]
  s_waitcnt lgkmcnt(6)
  v_cmp_gt_u32 vcc, 6, v14
  s_cbranch_vccnz L_ls19_o
L_ls19:
  ds_read_b128 v[96:99], v160 offset:16384
  ds_read_b64_tr_b16 v[208:209], v11 offset:40960
  v_mfma_f32_32x32x16_bf16 v[144:159], v[228:231], v[88:91], v[144:159]
  ds_read_b64_tr_b16 v[210:211], v11 offset:41472
  ds_read_b64_tr_b16 v[212:213], v15 offset:40960
  ds_read_b64_tr_b16 v[214:215], v15 offset:41472
  s_add_u32 m0, s57, 16384
  s_mul_i32 s56, s3, 172032
  buffer_load_dwordx4 v5, s[40:43], s56 offen lds
  s_add_u32 s3, s3, 1
  s_cmp_eq_u32 s3, 7
  s_cselect_b32 s3, 0, s3
  s_add_u32 m0, s57, 20480
  s_mul_i32 s56, s3, 172032
  buffer_load_dwordx4 v5, s[40:43], s56 offen lds
  s_add_u32 s3, s3, 1
  s_cmp_eq_u32 s3, 7
  s_cselect_b32 s3, 0, s3
  s_waitcnt lgkmcnt(6)
  v_mfma_f32_32x32x16_bf16 v[128:143], v[232:235], v[92:95], v[128:143]
  ds_read_b128 v[100:103], v161 offset:16384
  ds_read_b64_tr_b16 v[216:217], v11 offset:43008
  v_mfma_f32_32x32x16_bf16 v[144:159], v[236:239], v[92:95], v[144:159]
  ds_read_b64_tr_b16 v[218:219], v11 offset:43520
  ds_read_b64_tr_b16 v[220:221], v15 offset:43008
  ds_read_b64_tr_b16 v[222:223], v15 offset:43520
  s_add_u32 m0, s57, 24576
  s_mul_i32 s56, s3, 172032
  buffer_load_dwordx4 v5, s[40:43], s56 offen lds
  s_waitcnt lgkmcnt(5)
  v_mfma_f32_32x32x16_bf16 v[128:143], v[208:211], v[96:99], v[128:143]
  ds_read_b128 v[104:107], v162 offset:16384
  ds_read_b64_tr_b16 v[224:225], v11 offset:45056
  v_mfma_f32_32x32x16_bf16 v[144:159], v[212:215], v[96:99], v[144:159]
  ds_read_b64_tr_b16 v[226:227], v11 offset:45568
  ds_read_b64_tr_b16 v[228:229], v15 offset:45056
  ds_read_b64_tr_b16 v[230:231], v15 offset:45568
  s_waitcnt lgkmcnt(5)
  v_mfma_f32_32x32x16_bf16 v[128:143], v[216:219], v[100:103], v[128:143]
  ds_read_b32 v14, v241
  ds_read_b128 v[108:111], v163 offset:16384
  ds_read_b64_tr_b16 v[232:233], v11 offset:47104
  v_mfma_f32_32x32x16_bf16 v[144:159], v[220:223], v[100:103], v[144:159]
  ds_read_b64_tr_b16 v[234:235], v11 offset:47616
  ds_read_b64_tr_b16 v[236:237], v15 offset:47104
  ds_read_b64_tr_b16 v[238:239], v15 offset:47616
  v_mov_b32 v245, 6
  ds_write_b32 v243, v245
  s_waitcnt lgkmcnt(7)
  v_mfma_f32_32x32x16_bf16 v[128:143], v[224:227], v[104:107], v[128:143]
  s_waitcnt lgkmcnt(6)
  v_cmp_gt_u32 vcc, 7, v14
  s_cbranch_vccnz L_ls20_o
L_ls20:
  ds_read_b128 v[112:115], v6 offset:0
  ds_read_b64_tr_b16 v[208:209], v11 offset:49152
  v_mfma_f32_32x32x16_bf16 v[144:159], v[228:231], v[104:107], v[144:159]
  ds_read_b64_tr_b16 v[210:211], v11 offset:49664
  ds_read_b64_tr_b16 v[212:213], v15 offset:49152
  ds_read_b64_tr_b16 v[214:215], v15 offset:49664
  s_waitcnt lgkmcnt(6)
  v_mfma_f32_32x32x16_bf16 v[128:143], v[232:235], v[108:111], v[128:143]
  ds_read_b128 v[116:119], v7 offset:0
  ds_read_b64_tr_b16 v[216:217], v11 offset:51200
  v_mfma_f32_32x32x16_bf16 v[144:159], v[236:239], v[108:111], v[144:159]
  ds_read_b64_tr_b16 v[218:219], v11 offset:51712
  ds_read_b64_tr_b16 v[220:221], v15 offset:51200
  ds_read_b64_tr_b16 v[222:223], v15 offset:51712
  s_waitcnt lgkmcnt(5)
  v_mfma_f32_32x32x16_bf16 v[128:143], v[208:211], v[112:115], v[128:143]
  ds_read_b128 v[120:123], v8 offset:0
  ds_read_b64_tr_b16 v[224:225], v11 offset:53248
  v_mfma_f32_32x32x16_bf16 v[144:159], v[212:215], v[112:115], v[144:159]
  ds_read_b64_tr_b16 v[226:227], v11 offset:53760
  ds_read_b64_tr_b16 v[228:229], v15 offset:53248
  ds_read_b64_tr_b16 v[230:231], v15 offset:53760
  s_waitcnt lgkmcnt(5)
  v_mfma_f32_32x32x16_bf16 v[128:143], v[216:219], v[116:119], v[128:143]
  ds_read_b128 v[124:127], v9 offset:0
  ds_read_b64_tr_b16 v[232:233], v11 offset:55296
  v_mfma_f32_32x32x16_bf16 v[144:159], v[220:223], v[116:119], v[144:159]
  ds_read_b64_tr_b16 v[234:235], v11 offset:55808
  ds_read_b64_tr_b16 v[236:237], v15 offset:55296
  ds_read_b64_tr_b16 v[238:239], v15 offset:55808
  v_mov_b32 v245, 7
  ds_write_b32 v243, v245
  s_waitcnt lgkmcnt(6)
  v_mfma_f32_32x32x16_bf16 v[128:143], v[224:227], v[120:123], v[128:143]
  v_mfma_f32_32x32x16_bf16 v[144:159], v[228:231], v[120:123], v[144:159]
  s_lshl_b32 s52, s28, 4
  s_add_u32 s53, s52, s30
  s_lshl_b32 s53, s53, 16
  s_lshl_b32 s56, s62, 12
  s_add_u32 s53, s53, s56
  s_add_u32 s53, s53, 1048576
  s_cmp_eq_u32 s62, 7
  s_cselect_b32 s53, 1073741824, s53
  s_add_u32 s54, s53, 14336
  s_waitcnt lgkmcnt(1)
  v_mfma_f32_32x32x16_bf16 v[128:143], v[232:235], v[124:127], v[128:143]
  v_mfma_f32_32x32x16_bf16 v[144:159], v[236:239], v[124:127], v[144:159]
  s_nop 10
  v_cvt_pk_bf16_f32 v192, v128, v129
  v_cvt_pk_bf16_f32 v193, v130, v131
  v_cvt_pk_bf16_f32 v194, v132, v133
  v_cvt_pk_bf16_f32 v195, v134, v135
  buffer_store_dwordx4 v[192:195], v13, s[32:35], s53 offen offset:0 sc1
  v_cvt_pk_bf16_f32 v196, v136, v137
  v_cvt_pk_bf16_f32 v197, v138, v139
  v_cvt_pk_bf16_f32 v198, v140, v141
  v_cvt_pk_bf16_f32 v199, v142, v143
  buffer_store_dwordx4 v[196:199], v13, s[32:35], s53 offen offset:1024 sc1
  v_cvt_pk_bf16_f32 v200, v144, v145
  v_cvt_pk_bf16_f32 v201, v146, v147
  v_cvt_pk_bf16_f32 v202, v148, v149
  v_cvt_pk_bf16_f32 v203, v150, v151
  buffer_store_dwordx4 v[200:203], v13, s[32:35], s53 offen offset:2048 sc1
  v_cvt_pk_bf16_f32 v204, v152, v153
  v_cvt_pk_bf16_f32 v205, v154, v155
  v_cvt_pk_bf16_f32 v206, v156, v157
  v_cvt_pk_bf16_f32 v207, v158, v159
  buffer_store_dwordx4 v[204:207], v13, s[32:35], s53 offen offset:3072 sc1
  s_waitcnt vmcnt(4)
  v_mov_b32 v245, 8
  ds_write_b32 v243, v245
  s_branch L_gj
L_ls14_o:
  s_mov_b32 s63, 65536
L_ls21:
  ds_read_b32 v14, v241
  s_sub_u32 s63, s63, 1
  s_cbranch_scc1 L_ls21_x
  s_waitcnt lgkmcnt(0)
  v_cmp_gt_u32 vcc, 2, v14
  s_cbranch_vccnz L_ls21
L_ls21_x:
  s_branch L_ls14
L_ls15_o:
  s_mov_b32 s63, 65536
L_ls22:
  ds_read_b32 v14, v241
  s_sub_u32 s63, s63, 1
  s_cbranch_scc1 L_ls22_x
  s_waitcnt lgkmcnt(0)
  v_cmp_gt_u32 vcc, 3, v14
  s_cbranch_vccnz L_ls22
L_ls22_x:
  s_branch L_ls15
L_ls16_o:
  s_mov_b32 s63, 65536
L_ls23:
  ds_read_b32 v14, v241
  s_sub_u32 s63, s63, 1
  s_cbranch_scc1 L_ls23_x
  s_waitcnt lgkmcnt(0)
  v_cmp_gt_u32 vcc, 4, v14
  s_cbranch_vccnz L_ls23
L_ls23_x:
  s_branch L_ls16
L_ls17_o:
  s_mov_b32 s63, 65536
L_ls24:
  ds_read_b32 v14, v241
  s_sub_u32 s63, s63, 1
  s_cbranch_scc1 L_ls24_x
  s_waitcnt lgkmcnt(0)
  v_cmp_gt_u32 vcc, 5, v14
  s_cbranch_vccnz L_ls24
L_ls24_x:
  s_branch L_ls17
L_ls18_o:
  s_mov_b32 s63, 65536
L_ls25:
  ds_read_b32 v4, v244
  s_sub_u32 s63, s63, 1
  s_cbranch_scc1 L_ls25_x
  s_waitcnt lgkmcnt(0)
  v_cmp_gt_u32 vcc, 4, v4
  s_cbranch_vccnz L_ls25
L_ls25_x:
  s_branch L_ls18
L_ls19_o:
  s_mov_b32 s63, 65536
L_ls26:
  ds_read_b32 v14, v241
  s_sub_u32 s63, s63, 1
  s_cbranch_scc1 L_ls26_x
  s_waitcnt lgkmcnt(0)
  v_cmp_gt_u32 vcc, 6, v14
  s_cbranch_vccnz L_ls26
L_ls26_x:
  s_branch L_ls19
L_ls20_o:
  s_mov_b32 s63, 65536
L_ls27:
  ds_read_b32 v14, v241
  s_sub_u32 s63, s63, 1
  s_cbranch_scc1 L_ls27_x
  s_waitcnt lgkmcnt(0)
  v_cmp_gt_u32 vcc, 7, v14
  s_cbranch_vccnz L_ls27
L_ls27_x:
  s_branch L_ls20
.p2align 6
L_gv:
  s_waitcnt lgkmcnt(5)
  v_mfma_f32_32x32x16_bf16 v[128:143], v[16:19], v[208:211], 0
  ds_read_b128 v[24:27], v8 offset:0
  ds_read_b64_tr_b16 v[224:225], v11 offset:4096
  v_mfma_f32_32x32x16_bf16 v[144:159], v[16:19], v[212:215], 0
  ds_read_b64_tr_b16 v[226:227], v11 offset:4608
  ds_read_b64_tr_b16 v[228:229], v15 offset:4096
  ds_read_b64_tr_b16 v[230:231], v15 offset:4608
  s_waitcnt lgkmcnt(5)
  v_mfma_f32_32x32x16_bf16 v[128:143], v[20:23], v[216:219], v[128:143]
  ds_read_b32 v14, v241
  ds_read_b128 v[28:31], v9 offset:0
  ds_read_b64_tr_b16 v[232:233], v11 offset:6144
  v_mfma_f32_32x32x16_bf16 v[144:159], v[20:23], v[220:223], v[144:159]
  ds_read_b64_tr_b16 v[234:235], v11 offset:6656
  ds_read_b64_tr_b16 v[236:237], v15 offset:6144
  ds_read_b64_tr_b16 v[238:239], v15 offset:6656
  v_mov_b32 v245, 1
  ds_write_b32 v243, v245
  s_waitcnt lgkmcnt(7)
  v_mfma_f32_32x32x16_bf16 v[128:143], v[24:27], v[224:227], v[128:143]
  s_waitcnt lgkmcnt(6)
  v_cmp_gt_u32 vcc, 2, v14
  s_cbranch_vccnz L_ls28_o
L_ls28:
  ds_read_b128 v[32:35], v6 offset:16384
  ds_read_b64_tr_b16 v[208:209], v11 offset:8192
  v_mfma_f32_32x32x16_bf16 v[144:159], v[24:27], v[228:231], v[144:159]
  ds_read_b64_tr_b16 v[210:211], v11 offset:8704
  ds_read_b64_tr_b16 v[212:213], v15 offset:8192
  ds_read_b64_tr_b16 v[214:215], v15 offset:8704
  s_waitcnt lgkmcnt(6)
  v_mfma_f32_32x32x16_bf16 v[128:143], v[28:31], v[232:235], v[128:143]
  ds_read_b128 v[36:39], v7 offset:16384
  ds_read_b64_tr_b16 v[216:217], v11 offset:10240
  v_mfma_f32_32x32x16_bf16 v[144:159], v[28:31], v[236:239], v[144:159]
  ds_read_b64_tr_b16 v[218:219], v11 offset:10752
  ds_read_b64_tr_b16 v[220:221], v15 offset:10240
  ds_read_b64_tr_b16 v[222:223], v15 offset:10752
  s_waitcnt lgkmcnt(5)
  v_mfma_f32_32x32x16_bf16 v[128:143], v[32:35], v[208:211], v[128:143]
  ds_read_b128 v[40:43], v8 offset:16384
  ds_read_b64_tr_b16 v[224:225], v11 offset:12288
  v_mfma_f32_32x32x16_bf16 v[144:159], v[32:35], v[212:215], v[144:159]
  ds_read_b64_tr_b16 v[226:227], v11 offset:12800
  ds_read_b64_tr_b16 v[228:229], v15 offset:12288
  ds_read_b64_tr_b16 v[230:231], v15 offset:12800
  s_waitcnt lgkmcnt(5)
  v_mfma_f32_32x32x16_bf16 v[128:143], v[36:39], v[216:219], v[128:143]
  ds_read_b32 v14, v241
  ds_read_b128 v[44:47], v9 offset:16384
  ds_read_b64_tr_b16 v[232:233], v11 offset:14336
  v_mfma_f32_32x32x16_bf16 v[144:159], v[36:39], v[220:223], v[144:159]
  ds_read_b64_tr_b16 v[234:235], v11 offset:14848
  ds_read_b64_tr_b16 v[236:237], v15 offset:14336
  ds_read_b64_tr_b16 v[238:239], v15 offset:14848
  v_mov_b32 v245, 2
  ds_write_b32 v243, v245
  s_waitcnt lgkmcnt(7)
  v_mfma_f32_32x32x16_bf16 v[128:143], v[40:43], v[224:227], v[128:143]
  s_waitcnt lgkmcnt(6)
  v_cmp_gt_u32 vcc, 3, v14
  s_cbranch_vccnz L_ls29_o
L_ls29:
  ds_read_b128 v[48:51], v6 offset:32768
  ds_read_b64_tr_b16 v[208:209], v11 offset:16384
  v_mfma_f32_32x32x16_bf16 v[144:159], v[40:43], v[228:231], v[144:159]
  ds_read_b64_tr_b16 v[210:211], v11 offset:16896
  ds_read_b64_tr_b16 v[212:213], v15 offset:16384
  ds_read_b64_tr_b16 v[214:215], v15 offset:16896
  s_waitcnt lgkmcnt(6)
  v_mfma_f32_32x32x16_bf16 v[128:143], v[44:47], v[232:235], v[128:143]
  ds_read_b128 v[52:55], v7 offset:32768
  ds_read_b64_tr_b16 v[216:217], v11 offset:18432
  v_mfma_f32_32x32x16_bf16 v[144:159], v[44:47], v[236:239], v[144:159]
  ds_read_b64_tr_b16 v[218:219], v11 offset:18944
  ds_read_b64_tr_b16 v[220:221], v15 offset:18432
  ds_read_b64_tr_b16 v[222:223], v15 offset:18944
  s_waitcnt lgkmcnt(5)
  v_mfma_f32_32x32x16_bf16 v[128:143], v[48:51], v[208:211], v[128:143]
  ds_read_b128 v[56:59], v8 offset:32768
  ds_read_b64_tr_b16 v[224:225], v11 offset:20480
  v_mfma_f32_32x32x16_bf16 v[144:159], v[48:51], v[212:215], v[144:159]
  ds_read_b64_tr_b16 v[226:227], v11 offset:20992
  ds_read_b64_tr_b16 v[228:229], v15 offset:20480
  ds_read_b64_tr_b16 v[230:231], v15 offset:20992
  s_waitcnt lgkmcnt(5)
  v_mfma_f32_32x32x16_bf16 v[128:143], v[52:55], v[216:219], v[128:143]
  ds_read_b32 v14, v241
  ds_read_b128 v[60:63], v9 offset:32768
  ds_read_b64_tr_b16 v[232:233], v11 offset:22528
  v_mfma_f32_32x32x16_bf16 v[144:159], v[52:55], v[220:223], v[144:159]
  ds_read_b64_tr_b16 v[234:235], v11 offset:23040
  ds_read_b64_tr_b16 v[236:237], v15 offset:22528
  ds_read_b64_tr_b16 v[238:239], v15 offset:23040
  v_mov_b32 v245, 3
  ds_write_b32 v243, v245
  s_waitcnt lgkmcnt(7)
  v_mfma_f32_32x32x16_bf16 v[128:143], v[56:59], v[224:227], v[128:143]
  s_waitcnt lgkmcnt(6)
  v_cmp_gt_u32 vcc, 4, v14
  s_cbranch_vccnz L_ls30_o
L_ls30:
  ds_read_b128 v[64:67], v6 offset:49152
  ds_read_b64_tr_b16 v[208:209], v11 offset:24576
  v_mfma_f32_32x32x16_bf16 v[144:159], v[56:59], v[228:231], v[144:159]
  ds_read_b64_tr_b16 v[210:211], v11 offset:25088
  ds_read_b64_tr_b16 v[212:213], v15 offset:24576
  ds_read_b64_tr_b16 v[214:215], v15 offset:25088
  s_waitcnt lgkmcnt(6)
  v_mfma_f32_32x32x16_bf16 v[128:143], v[60:63], v[232:235], v[128:143]
  ds_read_b128 v[68:71], v7 offset:49152
  ds_read_b64_tr_b16 v[216:217], v11 offset:26624
  v_mfma_f32_32x32x16_bf16 v[144:159], v[60:63], v[236:239], v[144:159]
  ds_read_b64_tr_b16 v[218:219], v11 offset:27136
  ds_read_b64_tr_b16 v[220:221], v15 offset:26624
  ds_read_b64_tr_b16 v[222:223], v15 offset:27136
  buffer_store_dword v12, v242, s[32:35], 0 offen sc1
  buffer_store_dwordx4 v[248:251], v13, s[32:35], s55 offen offset:0 sc1
  buffer_store_dwordx4 v[248:251], v13, s[32:35], s55 offen offset:1024 sc1
  s_waitcnt lgkmcnt(5)
  v_mfma_f32_32x32x16_bf16 v[128:143], v[64:67], v[208:211], v[128:143]
  ds_read_b128 v[72:75], v8 offset:49152
  ds_read_b64_tr_b16 v[224:225], v11 offset:28672
  v_mfma_f32_32x32x16_bf16 v[144:159], v[64:67], v[212:215], v[144:159]
  ds_read_b64_tr_b16 v[226:227], v11 offset:29184
  ds_read_b64_tr_b16 v[228:229], v15 offset:28672
  ds_read_b64_tr_b16 v[230:231], v15 offset:29184
  s_waitcnt lgkmcnt(5)
  v_mfma_f32_32x32x16_bf16 v[128:143], v[68:71], v[216:219], v[128:143]
  ds_read_b32 v14, v241
  ds_read_b128 v[76:79], v9 offset:49152
  ds_read_b64_tr_b16 v[232:233], v11 offset:30720
  v_mfma_f32_32x32x16_bf16 v[144:159], v[68:71], v[220:223], v[144:159]
  ds_read_b64_tr_b16 v[234:235], v11 offset:31232
  ds_read_b64_tr_b16 v[236:237], v15 offset:30720
  ds_read_b64_tr_b16 v[238:239], v15 offset:31232
  v_mov_b32 v245, 4
  ds_write_b32 v243, v245
  s_waitcnt lgkmcnt(7)
  v_mfma_f32_32x32x16_bf16 v[128:143], v[72:75], v[224:227], v[128:143]
  s_waitcnt lgkmcnt(6)
  v_cmp_gt_u32 vcc, 5, v14
  s_cbranch_vccnz L_ls31_o
L_ls31:
  ds_read_b128 v[80:83], v160 offset:0
  ds_read_b64_tr_b16 v[208:209], v11 offset:32768
  v_mfma_f32_32x32x16_bf16 v[144:159], v[72:75], v[228:231], v[144:159]
  ds_read_b64_tr_b16 v[210:211], v11 offset:33280
  ds_read_b64_tr_b16 v[212:213], v15 offset:32768
  ds_read_b64_tr_b16 v[214:215], v15 offset:33280
  ds_read_b32 v4, v244
  s_waitcnt lgkmcnt(7)
  v_mfma_f32_32x32x16_bf16 v[128:143], v[76:79], v[232:235], v[128:143]
  ds_read_b128 v[84:87], v161 offset:0
  ds_read_b64_tr_b16 v[216:217], v11 offset:34816
  v_mfma_f32_32x32x16_bf16 v[144:159], v[76:79], v[236:239], v[144:159]
  ds_read_b64_tr_b16 v[218:219], v11 offset:35328
  ds_read_b64_tr_b16 v[220:221], v15 offset:34816
  ds_read_b64_tr_b16 v[222:223], v15 offset:35328
  s_waitcnt lgkmcnt(6)
  v_mfma_f32_32x32x16_bf16 v[128:143], v[80:83], v[208:211], v[128:143]
  ds_read_b128 v[88:91], v162 offset:0
  ds_read_b64_tr_b16 v[224:225], v11 offset:36864
  v_mfma_f32_32x32x16_bf16 v[144:159], v[80:83], v[212:215], v[144:159]
  ds_read_b64_tr_b16 v[226:227], v11 offset:37376
  ds_read_b64_tr_b16 v[228:229], v15 offset:36864
  ds_read_b64_tr_b16 v[230:231], v15 offset:37376
  s_waitcnt lgkmcnt(10)
  v_cmp_gt_u32 vcc, 4, v4
  s_lshl_b32 s57, s28, 10
  s_cbranch_vccnz L_ls32_o
L_ls32:
  s_add_u32 m0, s57, 0
  s_mul_i32 s56, s3, 172032
  buffer_load_dwordx4 v5, s[40:43], s56 offen lds
  s_add_u32 s3, s3, 1
  s_cmp_eq_u32 s3, 7
  s_cselect_b32 s3, 0, s3
  s_add_u32 m0, s57, 4096
  s_mul_i32 s56, s3, 172032
  buffer_load_dwordx4 v5, s[40:43], s56 offen lds
  s_add_u32 s3, s3, 1
  s_cmp_eq_u32 s3, 7
  s_cselect_b32 s3, 0, s3
  s_waitcnt lgkmcnt(5)
  v_mfma_f32_32x32x16_bf16 v[128:143], v[84:87], v[216:219], v[128:143]
  ds_read_b32 v14, v241
  ds_read_b128 v[92:95], v163 offset:0
  ds_read_b64_tr_b16 v[232:233], v11 offset:38912
  v_mfma_f32_32x32x16_bf16 v[144:159], v[84:87], v[220:223], v[144:159]
  ds_read_b64_tr_b16 v[234:235], v11 offset:39424
  ds_read_b64_tr_b16 v[236:237], v15 offset:38912
  ds_read_b64_tr_b16 v[238:239], v15 offset:39424
  v_mov_b32 v245, 5
  ds_write_b32 v243, v245
  s_add_u32 m0, s57, 8192
  s_mul_i32 s56, s3, 172032
  buffer_load_dwordx4 v5, s[40:43], s56 offen lds
  s_add_u32 s3, s3, 1
  s_cmp_eq_u32 s3, 7
  s_cselect_b32 s3, 0, s3
  s_add_u32 m0, s57, 12288
  s_mul_i32 s56, s3, 172032
  buffer_load_dwordx4 v5, s[40:43], s56 offen lds
  s_add_u32 s3, s3, 1
  s_cmp_eq_u32 s3, 7
  s_cselect_b32 s3, 0, s3
  s_waitcnt lgkmcnt(7)
  v_mfma_f32_32x32x16_bf16 v[128:143], v[88:91], v[224:227], v[128:143]
  s_waitcnt lgkmcnt(6)
  v_cmp_gt_u32 vcc, 6, v14
  s_cbranch_vccnz L_ls33_o
L_ls33:
  ds_read_b128 v[96:99], v160 offset:16384
  ds_read_b64_tr_b16 v[208:209], v11 offset:40960
  v_mfma_f32_32x32x16_bf16 v[144:159], v[88:91], v[228:231], v[144:159]
  ds_read_b64_tr_b16 v[210:211], v11 offset:41472
  ds_read_b64_tr_b16 v[212:213], v15 offset:40960
  ds_read_b64_tr_b16 v[214:215], v15 offset:41472
  s_add_u32 m0, s57, 16384
  s_mul_i32 s56, s3, 172032
  buffer_load_dwordx4 v5, s[40:43], s56 offen lds
  s_add_u32 s3, s3, 1
  s_cmp_eq_u32 s3, 7
  s_cselect_b32 s3, 0, s3
  s_add_u32 m0, s57, 20480
  s_mul_i32 s56, s3, 172032
  buffer_load_dwordx4 v5, s[40:43], s56 offen lds
  s_add_u32 s3, s3, 1
  s_cmp_eq_u32 s3, 7
  s_cselect_b32 s3, 0, s3
  s_waitcnt lgkmcnt(6)
  v_mfma_f32_32x32x16_bf16 v[128:143], v[92:95], v[232:235], v[128:143]
  ds_read_b128 v[100:103], v161 offset:16384
  ds_read_b64_tr_b16 v[216:217], v11 offset:43008
  v_mfma_f32_32x32x16_bf16 v[144:159], v[92:95], v[236:239], v[144:159]
  ds_read_b64_tr_b16 v[218:219], v11 offset:43520
  ds_read_b64_tr_b16 v[220:221], v15 offset:43008
  ds_read_b64_tr_b16 v[222:223], v15 offset:43520
  s_add_u32 m0, s57, 24576
  s_mul_i32 s56, s3, 172032
  buffer_load_dwordx4 v5, s[40:43], s56 offen lds
  s_waitcnt lgkmcnt(5)
  v_mfma_f32_32x32x16_bf16 v[128:143], v[96:99], v[208:211], v[128:143]
  ds_read_b128 v[104:107], v162 offset:16384
  ds_read_b64_tr_b16 v[224:225], v11 offset:45056
  v_mfma_f32_32x32x16_bf16 v[144:159], v[96:99], v[212:215], v[144:159]
  ds_read_b64_tr_b16 v[226:227], v11 offset:45568
  ds_read_b64_tr_b16 v[228:229], v15 offset:45056
  ds_read_b64_tr_b16 v[230:231], v15 offset:45568
  s_waitcnt lgkmcnt(5)
  v_mfma_f32_32x32x16_bf16 v[128:143], v[100:103], v[216:219], v[128:143]
  ds_read_b32 v14, v241
  ds_read_b128 v[108:111], v163 offset:16384
  ds_read_b64_tr_b16 v[232:233], v11 offset:47104
  v_mfma_f32_32x32x16_bf16 v[144:159], v[100:103], v[220:223], v[144:159]
  ds_read_b64_tr_b16 v[234:235], v11 offset:47616
  ds_read_b64_tr_b16 v[236:237], v15 offset:47104
  ds_read_b64_tr_b16 v[238:239], v15 offset:47616
  v_mov_b32 v245, 6
  ds_write_b32 v243, v245
  s_waitcnt lgkmcnt(7)
  v_mfma_f32_32x32x16_bf16 v[128:143], v[104:107], v[224:227], v[128:143]
  s_waitcnt lgkmcnt(6)
  v_cmp_gt_u32 vcc, 7, v14
  s_cbranch_vccnz L_ls34_o
L_ls34:
  ds_read_b128 v[112:115], v6 offset:0
  ds_read_b64_tr_b16 v[208:209], v11 offset:49152
  v_mfma_f32_32x32x16_bf16 v[144:159], v[104:107], v[228:231], v[144:159]
  ds_read_b64_tr_b16 v[210:211], v11 offset:49664
  ds_read_b64_tr_b16 v[212:213], v15 offset:49152
  ds_read_b64_tr_b16 v[214:215], v15 offset:49664
  s_waitcnt lgkmcnt(6)
  v_mfma_f32_32x32x16_bf16 v[128:143], v[108:111], v[232:235], v[128:143]
  ds_read_b128 v[116:119], v7 offset:0
  ds_read_b64_tr_b16 v[216:217], v11 offset:51200
  v_mfma_f32_32x32x16_bf16 v[144:159], v[108:111], v[236:239], v[144:159]
  ds_read_b64_tr_b16 v[218:219], v11 offset:51712
  ds_read_b64_tr_b16 v[220:221], v15 offset:51200
  ds_read_b64_tr_b16 v[222:223], v15 offset:51712
  s_waitcnt lgkmcnt(5)
  v_mfma_f32_32x32x16_bf16 v[128:143], v[112:115], v[208:211], v[128:143]
  ds_read_b128 v[120:123], v8 offset:0
  ds_read_b64_tr_b16 v[224:225], v11 offset:53248
  v_mfma_f32_32x32x16_bf16 v[144:159], v[112:115], v[212:215], v[144:159]
  ds_read_b64_tr_b16 v[226:227], v11 offset:53760
  ds_read_b64_tr_b16 v[228:229], v15 offset:53248
  ds_read_b64_tr_b16 v[230:231], v15 offset:53760
  s_waitcnt lgkmcnt(5)
  v_mfma_f32_32x32x16_bf16 v[128:143], v[116:119], v[216:219], v[128:143]
  ds_read_b128 v[124:127], v9 offset:0
  ds_read_b64_tr_b16 v[232:233], v11 offset:55296
  v_mfma_f32_32x32x16_bf16 v[144:159], v[116:119], v[220:223], v[144:159]
  ds_read_b64_tr_b16 v[234:235], v11 offset:55808
  ds_read_b64_tr_b16 v[236:237], v15 offset:55296
  ds_read_b64_tr_b16 v[238:239], v15 offset:55808
  v_mov_b32 v245, 7
  ds_write_b32 v243, v245
  s_waitcnt lgkmcnt(6)
  v_mfma_f32_32x32x16_bf16 v[128:143], v[120:123], v[224:227], v[128:143]
  v_mfma_f32_32x32x16_bf16 v[144:159], v[120:123], v[228:231], v[144:159]
  s_lshl_b32 s52, s28, 4
  s_add_u32 s53, s52, s30
  s_lshl_b32 s53, s53, 16
  s_lshl_b32 s56, s62, 10
  s_add_u32 s53, s53, s56
  s_add_u32 s53, s53, 1081344
  s_cmp_eq_u32 s62, 7
  s_cselect_b32 s53, 1073741824, s53
  s_add_u32 s54, s53, 14336
  s_waitcnt lgkmcnt(1)
  v_mfma_f32_32x32x16_bf16 v[128:143], v[124:127], v[232:235], v[128:143]
  v_mfma_f32_32x32x16_bf16 v[144:159], v[124:127], v[236:239], v[144:159]
  s_nop 10
  v_cvt_pk_bf16_f32 v192, v128, v129
  v_cvt_pk_bf16_f32 v193, v130, v131
  v_cvt_pk_bf16_f32 v194, v132, v133
  v_cvt_pk_bf16_f32 v195, v134, v135
  buffer_store_dwordx4 v[192:195], v246, s[32:35], s53 offen offset:0 sc1
  v_cvt_pk_bf16_f32 v196, v136, v137
  v_cvt_pk_bf16_f32 v197, v138, v139
  v_cvt_pk_bf16_f32 v198, v140, v141
  v_cvt_pk_bf16_f32 v199, v142, v143
  buffer_store_dwordx4 v[196:199], v246, s[32:35], s54 offen offset:0 sc1
  v_cvt_pk_bf16_f32 v200, v144, v145
  v_cvt_pk_bf16_f32 v201, v146, v147
  v_cvt_pk_bf16_f32 v202, v148, v149
  v_cvt_pk_bf16_f32 v203, v150, v151
  buffer_store_dwordx4 v[200:203], v246, s[32:35], s53 offen offset:512 sc1
  v_cvt_pk_bf16_f32 v204, v152, v153
  v_cvt_pk_bf16_f32 v205, v154, v155
  v_cvt_pk_bf16_f32 v206, v156, v157
  v_cvt_pk_bf16_f32 v207, v158, v159
  buffer_store_dwordx4 v[204:207], v246, s[32:35], s54 offen offset:512 sc1
  s_waitcnt vmcnt(4)
  v_mov_b32 v245, 8
  ds_write_b32 v243, v245
  s_branch L_gj
L_ls28_o:
  s_mov_b32 s63, 65536
L_ls35:
  ds_read_b32 v14, v241
  s_sub_u32 s63, s63, 1
  s_cbranch_scc1 L_ls35_x
  s_waitcnt lgkmcnt(0)
  v_cmp_gt_u32 vcc, 2, v14
  s_cbranch_vccnz L_ls35
L_ls35_x:
  s_branch L_ls28
L_ls29_o:
  s_mov_b32 s63, 65536
L_ls36:
  ds_read_b32 v14, v241
  s_sub_u32 s63, s63, 1
  s_cbranch_scc1 L_ls36_x
  s_waitcnt lgkmcnt(0)
  v_cmp_gt_u32 vcc, 3, v14
  s_cbranch_vccnz L_ls36
L_ls36_x:
  s_branch L_ls29
L_ls30_o:
  s_mov_b32 s63, 65536
L_ls37:
  ds_read_b32 v14, v241
  s_sub_u32 s63, s63, 1
  s_cbranch_scc1 L_ls37_x
  s_waitcnt lgkmcnt(0)
  v_cmp_gt_u32 vcc, 4, v14
  s_cbranch_vccnz L_ls37
L_ls37_x:
  s_branch L_ls30
L_ls31_o:
  s_mov_b32 s63, 65536
L_ls38:
  ds_read_b32 v14, v241
  s_sub_u32 s63, s63, 1
  s_cbranch_scc1 L_ls38_x
  s_waitcnt lgkmcnt(0)
  v_cmp_gt_u32 vcc, 5, v14
  s_cbranch_vccnz L_ls38
L_ls38_x:
  s_branch L_ls31
L_ls32_o:
  s_mov_b32 s63, 65536
L_ls39:
  ds_read_b32 v4, v244
  s_sub_u32 s63, s63, 1
  s_cbranch_scc1 L_ls39_x
  s_waitcnt lgkmcnt(0)
  v_cmp_gt_u32 vcc, 4, v4
  s_cbranch_vccnz L_ls39
L_ls39_x:
  s_branch L_ls32
L_ls33_o:
  s_mov_b32 s63, 65536
L_ls40:
  ds_read_b32 v14, v241
  s_sub_u32 s63, s63, 1
  s_cbranch_scc1 L_ls40_x
  s_waitcnt lgkmcnt(0)
  v_cmp_gt_u32 vcc, 6, v14
  s_cbranch_vccnz L_ls40
L_ls40_x:
  s_branch L_ls33
L_ls34_o:
  s_mov_b32 s63, 65536
L_ls41:
  ds_read_b32 v14, v241
  s_sub_u32 s63, s63, 1
  s_cbranch_scc1 L_ls41_x
  s_waitcnt lgkmcnt(0)
  v_cmp_gt_u32 vcc, 7, v14
  s_cbranch_vccnz L_ls41
L_ls41_x:
  s_branch L_ls34
.p2align 6
L_gj:
  s_and_b32 s56, s2, 1
  s_lshl_b32 s56, s56, 3
  s_add_u32 s56, s56, s62
  s_lshl_b32 s56, s56, 4
  s_add_u32 s56, s56, s30
  s_lshl_b32 s56, s56, 7
  s_add_u32 s56, s56, 131072
  v_lshl_add_u32 v2, v1, 2, s56
  v_lshrrev_b32 v255, 5, v1
  v_lshl_or_b32 v2, v255, 30, v2
  s_mov_b32 s63, 65536
L_ls42:
  ds_read_b32 v14, v244
  s_sub_u32 s63, s63, 1
  s_cbranch_scc1 L_ls42_x
  s_waitcnt lgkmcnt(0)
  v_cmp_gt_u32 vcc, 8, v14
  s_cbranch_vccnz L_ls42
L_ls42_x:
  ds_read_b64_tr_b16 v[160:161], v10 offset:0
  ds_read_b64_tr_b16 v[162:163], v10 offset:256
  ds_read_b64_tr_b16 v[164:165], v10 offset:1024
  ds_read_b64_tr_b16 v[166:167], v10 offset:1280
  ds_read_b64_tr_b16 v[168:169], v10 offset:2048
  ds_read_b64_tr_b16 v[170:171], v10 offset:2304
  ds_read_b64_tr_b16 v[172:173], v10 offset:3072
  ds_read_b64_tr_b16 v[174:175], v10 offset:3328
  ds_read_b64_tr_b16 v[176:177], v10 offset:4096
  ds_read_b64_tr_b16 v[178:179], v10 offset:4352
  ds_read_b64_tr_b16 v[180:181], v10 offset:5120
  ds_read_b64_tr_b16 v[182:183], v10 offset:5376
  s_waitcnt lgkmcnt(10)
  v_mfma_f32_32x32x16_bf16 v[128:143], v[160:163], v[16:19], 0
  ds_read_b64_tr_b16 v[184:185], v10 offset:6144
  ds_read_b64_tr_b16 v[186:187], v10 offset:6400
  s_mul_i32 s53, s29, 7
  s_lshr_b32 s54, s53, 4
  s_add_u32 s56, s53, 6
  s_waitcnt lgkmcnt(10)
  v_mfma_f32_32x32x16_bf16 v[144:159], v[164:167], v[20:23], 0
  ds_read_b64_tr_b16 v[188:189], v10 offset:7168
  ds_read_b64_tr_b16 v[190:191], v10 offset:7424
  s_lshr_b32 s56, s56, 4
  s_cmp_eq_u32 s54, s56
  s_cselect_b32 s56, 7, s56
  s_waitcnt lgkmcnt(10)
  v_mfma_f32_32x32x16_bf16 v[128:143], v[168:171], v[24:27], v[128:143]
  ds_read_b64_tr_b16 v[160:161], v10 offset:8192
  ds_read_b64_tr_b16 v[162:163], v10 offset:8448
  s_bitcmp1_b32 s28, 0
  s_cselect_b32 s54, s56, s54
  s_and_b32 s56, s28, 2
  s_waitcnt lgkmcnt(10)
  v_mfma_f32_32x32x16_bf16 v[144:159], v[172:175], v[28:31], v[144:159]
  ds_read_b64_tr_b16 v[164:165], v10 offset:9216
  ds_read_b64_tr_b16 v[166:167], v10 offset:9472
  s_lshl_b32 s56, s56, 2
  s_add_u32 s54, s54, s56
  s_lshl_b32 s54, s54, 11
  s_waitcnt lgkmcnt(10)
  v_mfma_f32_32x32x16_bf16 v[128:143], v[176:179], v[32:35], v[128:143]
  ds_read_b64_tr_b16 v[168:169], v10 offset:10240
  ds_read_b64_tr_b16 v[170:171], v10 offset:10496
  s_add_u32 s54, s54, 131072
  v_lshrrev_b32 v4, 2, v1
  v_lshl_add_u32 v4, v4, 7, s54
  s_waitcnt lgkmcnt(10)
  v_mfma_f32_32x32x16_bf16 v[144:159], v[180:183], v[36:39], v[144:159]
  ds_read_b64_tr_b16 v[172:173], v10 offset:11264
  ds_read_b64_tr_b16 v[174:175], v10 offset:11520
  s_lshl_b32 s57, s28, 11
  s_add_u32 s57, s57, 49152
  v_add_u32 v5, s57, v13
  s_waitcnt lgkmcnt(10)
  v_mfma_f32_32x32x16_bf16 v[128:143], v[184:187], v[40:43], v[128:143]
  ds_read_b64_tr_b16 v[176:177], v10 offset:12288
  ds_read_b64_tr_b16 v[178:179], v10 offset:12544
  s_add_u32 s57, s28, 1
  s_and_b32 s57, s57, 3
  s_lshl_b32 s56, s57, 11
  s_waitcnt lgkmcnt(10)
  v_mfma_f32_32x32x16_bf16 v[144:159], v[188:191], v[44:47], v[144:159]
  ds_read_b64_tr_b16 v[180:181], v10 offset:13312
  ds_read_b64_tr_b16 v[182:183], v10 offset:13568
  s_add_u32 s56, s56, 49152
  s_mul_i32 s57, s57, 12288
  v_add_u32 v6, s57, v13
  s_waitcnt lgkmcnt(10)
  v_mfma_f32_32x32x16_bf16 v[128:143], v[160:163], v[48:51], v[128:143]
  ds_read_b64_tr_b16 v[184:185], v10 offset:14336
  ds_read_b64_tr_b16 v[186:187], v10 offset:14592
  v_add_u32 v9, s56, v13
  s_add_u32 s57, s28, 2
  s_and_b32 s57, s57, 3
  s_waitcnt lgkmcnt(10)
  v_mfma_f32_32x32x16_bf16 v[144:159], v[164:167], v[52:55], v[144:159]
  ds_read_b64_tr_b16 v[188:189], v10 offset:15360
  ds_read_b64_tr_b16 v[190:191], v10 offset:15616
  s_lshl_b32 s56, s57, 11
  s_add_u32 s56, s56, 49152
  s_mul_i32 s57, s57, 12288
  s_waitcnt lgkmcnt(10)
  v_mfma_f32_32x32x16_bf16 v[128:143], v[168:171], v[56:59], v[128:143]
  ds_read_b64_tr_b16 v[160:161], v10 offset:16384
  ds_read_b64_tr_b16 v[162:163], v10 offset:16640
  v_add_u32 v7, s57, v13
  v_add_u32 v11, s56, v13
  s_add_u32 s57, s28, 3
  s_waitcnt lgkmcnt(10)
  v_mfma_f32_32x32x16_bf16 v[144:159], v[172:175], v[60:63], v[144:159]
  ds_read_b64_tr_b16 v[164:165], v10 offset:17408
  ds_read_b64_tr_b16 v[166:167], v10 offset:17664
  s_and_b32 s57, s57, 3
  s_lshl_b32 s56, s57, 11
  s_add_u32 s56, s56, 49152
  s_waitcnt lgkmcnt(10)
  v_mfma_f32_32x32x16_bf16 v[128:143], v[176:179], v[64:67], v[128:143]
  ds_read_b64_tr_b16 v[168:169], v10 offset:18432
  ds_read_b64_tr_b16 v[170:171], v10 offset:18688
  s_mul_i32 s57, s57, 12288
  v_add_u32 v8, s57, v13
  v_add_u32 v15, s56, v13
  s_waitcnt lgkmcnt(10)
  v_mfma_f32_32x32x16_bf16 v[144:159], v[180:183], v[68:71], v[144:159]
  ds_read_b64_tr_b16 v[172:173], v10 offset:19456
  ds_read_b64_tr_b16 v[174:175], v10 offset:19712
  s_lshl_b32 s52, s52, 16
  s_add_u32 s52, s52, 1048576
  s_lshr_b32 s56, s53, 1
  s_waitcnt lgkmcnt(10)
  v_mfma_f32_32x32x16_bf16 v[128:143], v[184:187], v[72:75], v[128:143]
  ds_read_b64_tr_b16 v[176:177], v10 offset:20480
  ds_read_b64_tr_b16 v[178:179], v10 offset:20736
  s_lshl_b32 s56, s56, 9
  s_add_u32 s56, s56, s52
  v_add_u32 v0, s56, v13
  s_waitcnt vmcnt(0)
  v_mov_b32 v245, 9
  ds_write_b32 v243, v245
  ds_read_b32 v14, v244
  s_waitcnt lgkmcnt(0)
  v_cmp_gt_u32 vcc, 9, v14
  s_nop 0
  s_cmp_eq_u64 vcc, 0
  s_cselect_b32 s3, 0, 1073741824
  buffer_store_dword v3, v2, s[32:35], s3 offen sc1
  v_mfma_f32_32x32x16_bf16 v[144:159], v[188:191], v[76:79], v[144:159]
  ds_read_b64_tr_b16 v[180:181], v10 offset:21504
  ds_read_b64_tr_b16 v[182:183], v10 offset:21760
  s_lshr_b32 s56, s53, 4
  s_lshl_b32 s56, s56, 7
  s_add_u32 s56, s56, s52
  v_mfma_f32_32x32x16_bf16 v[128:143], v[160:163], v[80:83], v[128:143]
  ds_read_b64_tr_b16 v[184:185], v10 offset:22528
  ds_read_b64_tr_b16 v[186:187], v10 offset:22784
  s_add_u32 s56, s56, 61440
  v_mov_b32 v1, s56
  s_and_b32 s42, s29, 1
  v_mfma_f32_32x32x16_bf16 v[144:159], v[164:167], v[84:87], v[144:159]
  ds_read_b64_tr_b16 v[188:189], v10 offset:23552
  ds_read_b64_tr_b16 v[190:191], v10 offset:23808
  s_sub_u32 s41, 0, s42
  s_sub_u32 s42, s42, 1
  s_mov_b32 s40, -1
  v_mfma_f32_32x32x16_bf16 v[128:143], v[168:171], v[88:91], v[128:143]
  ds_read_b64_tr_b16 v[160:161], v10 offset:24576
  ds_read_b64_tr_b16 v[162:163], v10 offset:24832
  s_mov_b32 s43, -1
  s_lshl_b32 s56, s53, 6
  s_add_u32 s56, s56, s52
  v_mfma_f32_32x32x16_bf16 v[144:159], v[172:175], v[92:95], v[144:159]
  ds_read_b64_tr_b16 v[164:165], v10 offset:25600
  ds_read_b64_tr_b16 v[166:167], v10 offset:25856
  s_add_u32 s56, s56, 32768
  s_and_b32 s57, s30, 12
  s_lshl_b32 s57, s57, 16
  v_mfma_f32_32x32x16_bf16 v[128:143], v[176:179], v[96:99], v[128:143]
  ds_read_b64_tr_b16 v[168:169], v10 offset:26624
  ds_read_b64_tr_b16 v[170:171], v10 offset:26880
  s_mov_b32 s44, s26
  s_mov_b32 s45, s27
  s_mov_b32 s46, 16777216
  s_waitcnt lgkmcnt(10)
  v_mfma_f32_32x32x16_bf16 v[144:159], v[180:183], v[100:103], v[144:159]
  ds_read_b64_tr_b16 v[172:173], v10 offset:27648
  ds_read_b64_tr_b16 v[174:175], v10 offset:27904
  s_mov_b32 s47, 0x20000
  s_waitcnt lgkmcnt(10)
  v_mfma_f32_32x32x16_bf16 v[128:143], v[184:187], v[104:107], v[128:143]
  s_waitcnt lgkmcnt(8)
  v_mfma_f32_32x32x16_bf16 v[144:159], v[188:191], v[108:111], v[144:159]
  s_waitcnt lgkmcnt(6)
  v_mfma_f32_32x32x16_bf16 v[128:143], v[160:163], v[112:115], v[128:143]
  s_waitcnt lgkmcnt(4)
  v_mfma_f32_32x32x16_bf16 v[144:159], v[164:167], v[116:119], v[144:159]
  s_waitcnt lgkmcnt(2)
  v_mfma_f32_32x32x16_bf16 v[128:143], v[168:171], v[120:123], v[128:143]
  s_waitcnt lgkmcnt(0)
  v_mfma_f32_32x32x16_bf16 v[144:159], v[172:175], v[124:127], v[144:159]
  v_add_u32 v2, s56, v246
  v_add_u32 v3, 14336, v2
  v_cndmask_b32 v2, v1, v2, s[58:59]
  v_cndmask_b32 v3, v1, v3, s[58:59]
  s_mov_b32 s56, 0x3e8b97f6
  s_nop 6
  v_add_f32 v128, v128, v144
  v_add_f32 v129, v129, v145
  v_add_f32 v130, v130, v146
  v_add_f32 v131, v131, v147
  v_add_f32 v132, v132, v148
  v_add_f32 v133, v133, v149
  v_add_f32 v134, v134, v150
  v_add_f32 v135, v135, v151
  v_add_f32 v136, v136, v152
  v_add_f32 v137, v137, v153
  v_add_f32 v138, v138, v154
  v_add_f32 v139, v139, v155
  v_add_f32 v140, v140, v156
  v_add_f32 v141, v141, v157
  v_add_f32 v142, v142, v158
  v_add_f32 v143, v143, v159
  v_mul_f32 v128, s56, v128
  v_mul_f32 v129, s56, v129
  v_mul_f32 v130, s56, v130
  v_mul_f32 v131, s56, v131
  v_mul_f32 v132, s56, v132
  v_mul_f32 v133, s56, v133
  v_mul_f32 v134, s56, v134
  v_mul_f32 v135, s56, v135
  v_mul_f32 v136, s56, v136
  v_mul_f32 v137, s56, v137
  v_mul_f32 v138, s56, v138
  v_mul_f32 v139, s56, v139
  v_mul_f32 v140, s56, v140
  v_mul_f32 v141, s56, v141
  v_mul_f32 v142, s56, v142
  v_mul_f32 v143, s56, v143
  v_cvt_pk_bf16_f32 v184, v128, v129
  v_cvt_pk_bf16_f32 v185, v130, v131
  v_cvt_pk_bf16_f32 v186, v132, v133
  v_cvt_pk_bf16_f32 v187, v134, v135
  v_cvt_pk_bf16_f32 v188, v136, v137
  v_cvt_pk_bf16_f32 v189, v138, v139
  v_cvt_pk_bf16_f32 v190, v140, v141
  v_cvt_pk_bf16_f32 v191, v142, v143
  v_cndmask_b32 v184, 0, v184, s[42:43]
  v_cndmask_b32 v185, 0, v185, s[42:43]
  v_cndmask_b32 v190, 0, v190, s[40:41]
  v_cndmask_b32 v191, 0, v191, s[40:41]
  ds_write_b128 v5, v[184:187]
  ds_write_b128 v5, v[188:191] offset:1024
  v_mov_b32 v16, 0
  v_mov_b32 v17, 0
  v_mov_b32 v18, 0
  v_mov_b32 v19, 0
  v_mov_b32 v20, 0
  v_mov_b32 v21, 0
  v_mov_b32 v22, 0
  v_mov_b32 v23, 0
  v_mov_b32 v24, 0
  v_mov_b32 v25, 0
  v_mov_b32 v26, 0
  v_mov_b32 v27, 0
  v_mov_b32 v28, 0
  v_mov_b32 v29, 0
  v_mov_b32 v30, 0
  v_mov_b32 v31, 0
  v_mov_b32 v32, 0
  v_mov_b32 v33, 0
  v_mov_b32 v34, 0
  v_mov_b32 v35, 0
  v_mov_b32 v36, 0
  v_mov_b32 v37, 0
  v_mov_b32 v38, 0
  v_mov_b32 v39, 0
  v_mov_b32 v40, 0
  v_mov_b32 v41, 0
  v_mov_b32 v42, 0
  v_mov_b32 v43, 0
  v_mov_b32 v44, 0
  v_mov_b32 v45, 0
  v_mov_b32 v46, 0
  v_mov_b32 v47, 0
  v_mov_b32 v48, 0
  v_mov_b32 v49, 0
  v_mov_b32 v50, 0
  v_mov_b32 v51, 0
  v_mov_b32 v52, 0
  v_mov_b32 v53, 0
  v_mov_b32 v54, 0
  v_mov_b32 v55, 0
  s_mov_b32 s63, 65536
L_poll43:
  buffer_load_dword v14, v4, s[32:35], 0 offen sc1
  s_sub_u32 s63, s63, 1
  s_cbranch_scc1 L_poll43_x
  s_waitcnt vmcnt(0)
  v_cmp_ne_u32 vcc, s31, v14
  s_cbranch_vccnz L_poll43
L_poll43_x:
L_hf:
  v_mov_b32 v245, 10
  ds_write_b32 v243, v245
  s_mov_b32 s63, 65536
L_ls44:
  ds_read_b32 v14, v244
  s_sub_u32 s63, s63, 1
  s_cbranch_scc1 L_ls44_x
  s_waitcnt lgkmcnt(0)
  v_cmp_gt_u32 vcc, 10, v14
  s_cbranch_vccnz L_ls44
L_ls44_x:
  buffer_load_dwordx4 v[192:195], v0, s[44:47], s57 offen offset:0 sc1
  buffer_load_dwordx4 v[196:199], v0, s[44:47], s57 offen offset:1024 sc1
  buffer_load_dwordx4 v[200:203], v2, s[44:47], s57 offen sc1
  buffer_load_dwordx4 v[204:207], v3, s[44:47], s57 offen sc1
  s_add_u32 s57, s57, 65536
  buffer_load_dwordx4 v[208:211], v0, s[44:47], s57 offen offset:0 sc1
  buffer_load_dwordx4 v[212:215], v0, s[44:47], s57 offen offset:1024 sc1
  buffer_load_dwordx4 v[216:219], v2, s[44:47], s57 offen sc1
  buffer_load_dwordx4 v[220:223], v3, s[44:47], s57 offen sc1
  s_add_u32 s57, s57, 65536
  buffer_load_dwordx4 v[224:227], v0, s[44:47], s57 offen offset:0 sc1
  buffer_load_dwordx4 v[228:231], v0, s[44:47], s57 offen offset:1024 sc1
  buffer_load_dwordx4 v[232:235], v2, s[44:47], s57 offen sc1
  buffer_load_dwordx4 v[236:239], v3, s[44:47], s57 offen sc1
  s_add_u32 s57, s57, 65536
  ds_read_b128 v[160:163], v9
  ds_read_b128 v[164:167], v9 offset:1024
  ds_read_b128 v[168:171], v11
  ds_read_b128 v[172:175], v11 offset:1024
  ds_read_b128 v[176:179], v15
  ds_read_b128 v[180:183], v15 offset:1024
  v_mov_b32 v245, 11
  ds_write_b32 v243, v245
  v_mov_b32 v56, 0
  v_mov_b32 v57, 0
  v_mov_b32 v58, 0
  v_mov_b32 v59, 0
  v_mov_b32 v60, 0
  v_mov_b32 v61, 0
  v_mov_b32 v62, 0
  v_mov_b32 v63, 0
  v_mov_b32 v64, 0
  v_mov_b32 v65, 0
  v_mov_b32 v66, 0
  v_mov_b32 v67, 0
  v_mov_b32 v68, 0
  v_mov_b32 v69, 0
  v_mov_b32 v70, 0
  v_mov_b32 v71, 0
  v_mov_b32 v72, 0
  v_mov_b32 v73, 0
  v_mov_b32 v74, 0
  v_mov_b32 v75, 0
  v_mov_b32 v76, 0
  v_mov_b32 v77, 0
  v_mov_b32 v78, 0
  v_mov_b32 v79, 0
  v_mov_b32 v108, 0
  v_mov_b32 v109, 0
  v_mov_b32 v110, 0
  v_mov_b32 v111, 0
  v_mov_b32 v112, 0
  v_mov_b32 v113, 0
  v_mov_b32 v114, 0
  v_mov_b32 v115, 0
  v_mov_b32 v116, 0
  v_mov_b32 v117, 0
  v_mov_b32 v118, 0
  v_mov_b32 v119, 0
  v_mov_b32 v248, 0
  v_mov_b32 v249, 0
  v_mov_b32 v250, 0
  v_mov_b32 v251, 0
  v_mov_b32 v252, 0
  v_mov_b32 v253, 0
  v_mov_b32 v254, 0
  v_mov_b32 v255, 0
  s_waitcnt vmcnt(8) lgkmcnt(0)
  v_mfma_f32_32x32x16_bf16 v[80:95], v[192:195], v[160:163], 0
  s_mov_b32 s62, 4
  s_setprio 1
  v_mfma_f32_32x32x16_bf16 v[80:95], v[196:199], v[164:167], v[80:95]
  s_nop 8
  s_branch L_att
.p2align 6
L_top:
  v_mfma_f32_32x32x16_bf16 v[32:47], v[248:251], v[112:115], v[32:47]
  v_cvt_pk_bf16_f32 v118, v108, v109
  v_cvt_pk_bf16_f32 v119, v110, v111
  v_exp_f32 v80, v80
  v_exp_f32 v81, v81
  v_exp_f32 v82, v82
  v_exp_f32 v83, v83
  v_mfma_f32_32x32x16_bf16 v[96:111], v[240:243], v[184:187], 0
  v_cvt_pk_bf16_f32 v112, v80, v81
  v_cvt_pk_bf16_f32 v113, v82, v83
  v_exp_f32 v84, v84
  v_exp_f32 v85, v85
  v_exp_f32 v86, v86
  v_exp_f32 v87, v87
  v_mfma_f32_32x32x16_bf16 v[96:111], v[244:247], v[188:191], v[96:111]
  buffer_load_dwordx4 v[236:239], v3, s[44:47], s57 offen sc1
  v_cvt_pk_bf16_f32 v114, v84, v85
  v_cvt_pk_bf16_f32 v115, v86, v87
  v_exp_f32 v88, v88
  v_exp_f32 v89, v89
  v_exp_f32 v90, v90
  v_exp_f32 v91, v91
  v_mfma_f32_32x32x16_bf16 v[32:47], v[252:255], v[116:119], v[32:47]
  v_cvt_pk_bf16_f32 v116, v88, v89
  v_cvt_pk_bf16_f32 v117, v90, v91
  v_exp_f32 v92, v92
  v_exp_f32 v93, v93
  v_exp_f32 v94, v94
  v_exp_f32 v95, v95
  v_mfma_f32_32x32x16_bf16 v[48:63], v[248:251], v[112:115], v[48:63]
  s_waitcnt vmcnt(8)
  v_cvt_pk_bf16_f32 v118, v92, v93
  v_cvt_pk_bf16_f32 v119, v94, v95
  v_exp_f32 v96, v96
  v_exp_f32 v97, v97
  v_exp_f32 v98, v98
  v_exp_f32 v99, v99
  v_mfma_f32_32x32x16_bf16 v[80:95], v[192:195], v[160:163], 0
  s_sub_u32 s62, s62, 1
  v_cvt_pk_bf16_f32 v112, v96, v97
  v_cvt_pk_bf16_f32 v113, v98, v99
  v_exp_f32 v100, v100
  v_exp_f32 v101, v101
  v_exp_f32 v102, v102
  v_exp_f32 v103, v103
  v_mfma_f32_32x32x16_bf16 v[80:95], v[196:199], v[164:167], v[80:95]
  v_cvt_pk_bf16_f32 v114, v100, v101
  v_cvt_pk_bf16_f32 v115, v102, v103
  v_exp_f32 v104, v104
  v_exp_f32 v105, v105
  v_exp_f32 v106, v106
  v_exp_f32 v107, v107
  v_mfma_f32_32x32x16_bf16 v[48:63], v[252:255], v[116:119], v[48:63]
  s_add_u32 s57, s57, 65536
  v_cvt_pk_bf16_f32 v116, v104, v105
  v_cvt_pk_bf16_f32 v117, v106, v107
  v_exp_f32 v108, v108
  v_exp_f32 v109, v109
  v_exp_f32 v110, v110
  v_exp_f32 v111, v111
L_att:
  v_mfma_f32_32x32x16_bf16 v[64:79], v[248:251], v[112:115], v[64:79]
  v_cvt_pk_bf16_f32 v118, v108, v109
  v_cvt_pk_bf16_f32 v119, v110, v111
  v_exp_f32 v80, v80
  v_exp_f32 v81, v81
  v_exp_f32 v82, v82
  v_exp_f32 v83, v83
  v_mfma_f32_32x32x16_bf16 v[96:111], v[192:195], v[168:171], 0
  buffer_load_dwordx4 v[240:243], v0, s[44:47], s57 offen offset:0 sc1
  v_cvt_pk_bf16_f32 v112, v80, v81
  v_cvt_pk_bf16_f32 v113, v82, v83
  v_exp_f32 v84, v84
  v_exp_f32 v85, v85
  v_exp_f32 v86, v86
  v_exp_f32 v87, v87
  v_mfma_f32_32x32x16_bf16 v[96:111], v[196:199], v[172:175], v[96:111]
  v_cvt_pk_bf16_f32 v114, v84, v85
  v_cvt_pk_bf16_f32 v115, v86, v87
  v_exp_f32 v88, v88
  v_exp_f32 v89, v89
  v_exp_f32 v90, v90
  v_exp_f32 v91, v91
  v_mfma_f32_32x32x16_bf16 v[64:79], v[252:255], v[116:119], v[64:79]
  v_cvt_pk_bf16_f32 v116, v88, v89
  v_cvt_pk_bf16_f32 v117, v90, v91
  v_exp_f32 v92, v92
  v_exp_f32 v93, v93
  v_exp_f32 v94, v94
  v_exp_f32 v95, v95
  v_mfma_f32_32x32x16_bf16 v[16:31], v[200:203], v[112:115], v[16:31]
  v_cvt_pk_bf16_f32 v118, v92, v93
  v_cvt_pk_bf16_f32 v119, v94, v95
  v_exp_f32 v96, v96
  v_exp_f32 v97, v97
  v_exp_f32 v98, v98
  v_exp_f32 v99, v99
  v_mfma_f32_32x32x16_bf16 v[80:95], v[192:195], v[176:179], 0
  buffer_load_dwordx4 v[244:247], v0, s[44:47], s57 offen offset:1024 sc1
  v_cvt_pk_bf16_f32 v112, v96, v97
  v_cvt_pk_bf16_f32 v113, v98, v99
  v_exp_f32 v100, v100
  v_exp_f32 v101, v101
  v_exp_f32 v102, v102
  v_exp_f32 v103, v103
  v_mfma_f32_32x32x16_bf16 v[80:95], v[196:199], v[180:183], v[80:95]
  buffer_load_dwordx4 v[248:251], v2, s[44:47], s57 offen sc1
  v_cvt_pk_bf16_f32 v114, v100, v101
  v_cvt_pk_bf16_f32 v115, v102, v103
  v_exp_f32 v104, v104
  v_exp_f32 v105, v105
  v_exp_f32 v106, v106
  v_exp_f32 v107, v107
  v_mfma_f32_32x32x16_bf16 v[16:31], v[204:207], v[116:119], v[16:31]
  v_cvt_pk_bf16_f32 v116, v104, v105
  v_cvt_pk_bf16_f32 v117, v106, v107
  v_exp_f32 v108, v108
  v_exp_f32 v109, v109
  v_exp_f32 v110, v110
  v_exp_f32 v111, v111
  v_mfma_f32_32x32x16_bf16 v[32:47], v[200:203], v[112:115], v[32:47]
  v_cvt_pk_bf16_f32 v118, v108, v109
  v_cvt_pk_bf16_f32 v119, v110, v111
  v_exp_f32 v80, v80
  v_exp_f32 v81, v81
  v_exp_f32 v82, v82
  v_exp_f32 v83, v83
  v_mfma_f32_32x32x16_bf16 v[96:111], v[192:195], v[184:187], 0
  v_cvt_pk_bf16_f32 v112, v80, v81
  v_cvt_pk_bf16_f32 v113, v82, v83
  v_exp_f32 v84, v84
  v_exp_f32 v85, v85
  v_exp_f32 v86, v86
  v_exp_f32 v87, v87
  v_mfma_f32_32x32x16_bf16 v[96:111], v[196:199], v[188:191], v[96:111]
  buffer_load_dwordx4 v[252:255], v3, s[44:47], s57 offen sc1
  v_cvt_pk_bf16_f32 v114, v84, v85
  v_cvt_pk_bf16_f32 v115, v86, v87
  v_exp_f32 v88, v88
  v_exp_f32 v89, v89
  v_exp_f32 v90, v90
  v_exp_f32 v91, v91
  v_mfma_f32_32x32x16_bf16 v[32:47], v[204:207], v[116:119], v[32:47]
  v_cvt_pk_bf16_f32 v116, v88, v89
  v_cvt_pk_bf16_f32 v117, v90, v91
  v_exp_f32 v92, v92
  v_exp_f32 v93, v93
  v_exp_f32 v94, v94
  v_exp_f32 v95, v95
  v_mfma_f32_32x32x16_bf16 v[48:63], v[200:203], v[112:115], v[48:63]
  s_waitcnt vmcnt(8)
  s_cmp_eq_u32 s62, 1
  v_cvt_pk_bf16_f32 v118, v92, v93
  v_cvt_pk_bf16_f32 v119, v94, v95
  v_exp_f32 v96, v96
  v_exp_f32 v97, v97
  v_exp_f32 v98, v98
  v_exp_f32 v99, v99
  v_mfma_f32_32x32x16_bf16 v[80:95], v[208:211], v[160:163], 0
  s_cselect_b32 s46, 0, s46
  v_cvt_pk_bf16_f32 v112, v96, v97
  v_cvt_pk_bf16_f32 v113, v98, v99
  v_exp_f32 v100, v100
  v_exp_f32 v101, v101
  v_exp_f32 v102, v102
  v_exp_f32 v103, v103
  v_mfma_f32_32x32x16_bf16 v[80:95], v[212:215], v[164:167], v[80:95]
  v_cvt_pk_bf16_f32 v114, v100, v101
  v_cvt_pk_bf16_f32 v115, v102, v103
  v_exp_f32 v104, v104
  v_exp_f32 v105, v105
  v_exp_f32 v106, v106
  v_exp_f32 v107, v107
  v_mfma_f32_32x32x16_bf16 v[48:63], v[204:207], v[116:119], v[48:63]
  s_add_u32 s57, s57, 65536
  v_cvt_pk_bf16_f32 v116, v104, v105
  v_cvt_pk_bf16_f32 v117, v106, v107
  v_exp_f32 v108, v108
  v_exp_f32 v109, v109
  v_exp_f32 v110, v110
  v_exp_f32 v111, v111
  v_mfma_f32_32x32x16_bf16 v[64:79], v[200:203], v[112:115], v[64:79]
  s_and_b32 s57, s57, 0xfffff
  v_cvt_pk_bf16_f32 v118, v108, v109
  v_cvt_pk_bf16_f32 v119, v110, v111
  v_exp_f32 v80, v80
  v_exp_f32 v81, v81
  v_exp_f32 v82, v82
  v_exp_f32 v83, v83
  v_mfma_f32_32x32x16_bf16 v[96:111], v[208:211], v[168:171], 0
  buffer_load_dwordx4 v[192:195], v0, s[44:47], s57 offen offset:0 sc1
  v_cvt_pk_bf16_f32 v112, v80, v81
  v_cvt_pk_bf16_f32 v113, v82, v83
  v_exp_f32 v84, v84
  v_exp_f32 v85, v85
  v_exp_f32 v86, v86
  v_exp_f32 v87, v87
  v_mfma_f32_32x32x16_bf16 v[96:111], v[212:215], v[172:175], v[96:111]
  v_cvt_pk_bf16_f32 v114, v84, v85
  v_cvt_pk_bf16_f32 v115, v86, v87
  v_exp_f32 v88, v88
  v_exp_f32 v89, v89
  v_exp_f32 v90, v90
  v_exp_f32 v91, v91
  v_mfma_f32_32x32x16_bf16 v[64:79], v[204:207], v[116:119], v[64:79]
  v_cvt_pk_bf16_f32 v116, v88, v89
  v_cvt_pk_bf16_f32 v117, v90, v91
  v_exp_f32 v92, v92
  v_exp_f32 v93, v93
  v_exp_f32 v94, v94
  v_exp_f32 v95, v95
  v_mfma_f32_32x32x16_bf16 v[16:31], v[216:219], v[112:115], v[16:31]
  v_cvt_pk_bf16_f32 v118, v92, v93
  v_cvt_pk_bf16_f32 v119, v94, v95
  v_exp_f32 v96, v96
  v_exp_f32 v97, v97
  v_exp_f32 v98, v98
  v_exp_f32 v99, v99
  v_mfma_f32_32x32x16_bf16 v[80:95], v[208:211], v[176:179], 0
  buffer_load_dwordx4 v[196:199], v0, s[44:47], s57 offen offset:1024 sc1
  v_cvt_pk_bf16_f32 v112, v96, v97
  v_cvt_pk_bf16_f32 v113, v98, v99
  v_exp_f32 v100, v100
  v_exp_f32 v101, v101
  v_exp_f32 v102, v102
  v_exp_f32 v103, v103
  v_mfma_f32_32x32x16_bf16 v[80:95], v[212:215], v[180:183], v[80:95]
  buffer_load_dwordx4 v[200:203], v2, s[44:47], s57 offen sc1
  v_cvt_pk_bf16_f32 v114, v100, v101
  v_cvt_pk_bf16_f32 v115, v102, v103
  v_exp_f32 v104, v104
  v_exp_f32 v105, v105
  v_exp_f32 v106, v106
  v_exp_f32 v107, v107
  v_mfma_f32_32x32x16_bf16 v[16:31], v[220:223], v[116:119], v[16:31]
  v_cvt_pk_bf16_f32 v116, v104, v105
  v_cvt_pk_bf16_f32 v117, v106, v107
  v_exp_f32 v108, v108
  v_exp_f32 v109, v109
  v_exp_f32 v110, v110
  v_exp_f32 v111, v111
  v_mfma_f32_32x32x16_bf16 v[32:47], v[216:219], v[112:115], v[32:47]
  v_cvt_pk_bf16_f32 v118, v108, v109
  v_cvt_pk_bf16_f32 v119, v110, v111
  v_exp_f32 v80, v80
  v_exp_f32 v81, v81
  v_exp_f32 v82, v82
  v_exp_f32 v83, v83
  v_mfma_f32_32x32x16_bf16 v[96:111], v[208:211], v[184:187], 0
  v_cvt_pk_bf16_f32 v112, v80, v81
  v_cvt_pk_bf16_f32 v113, v82, v83
  v_exp_f32 v84, v84
  v_exp_f32 v85, v85
  v_exp_f32 v86, v86
  v_exp_f32 v87, v87
  v_mfma_f32_32x32x16_bf16 v[96:111], v[212:215], v[188:191], v[96:111]
  buffer_load_dwordx4 v[204:207], v3, s[44:47], s57 offen sc1
  v_cvt_pk_bf16_f32 v114, v84, v85
  v_cvt_pk_bf16_f32 v115, v86, v87
  v_exp_f32 v88, v88
  v_exp_f32 v89, v89
  v_exp_f32 v90, v90
  v_exp_f32 v91, v91
  v_mfma_f32_32x32x16_bf16 v[32:47], v[220:223], v[116:119], v[32:47]
  v_cvt_pk_bf16_f32 v116, v88, v89
  v_cvt_pk_bf16_f32 v117, v90, v91
  v_exp_f32 v92, v92
  v_exp_f32 v93, v93
  v_exp_f32 v94, v94
  v_exp_f32 v95, v95
  v_mfma_f32_32x32x16_bf16 v[48:63], v[216:219], v[112:115], v[48:63]
  s_waitcnt vmcnt(8)
  v_cvt_pk_bf16_f32 v118, v92, v93
  v_cvt_pk_bf16_f32 v119, v94, v95
  v_exp_f32 v96, v96
  v_exp_f32 v97, v97
  v_exp_f32 v98, v98
  v_exp_f32 v99, v99
  v_mfma_f32_32x32x16_bf16 v[80:95], v[224:227], v[160:163], 0
  v_cvt_pk_bf16_f32 v112, v96, v97
  v_cvt_pk_bf16_f32 v113, v98, v99
  v_exp_f32 v100, v100
  v_exp_f32 v101, v101
  v_exp_f32 v102, v102
  v_exp_f32 v103, v103
  v_mfma_f32_32x32x16_bf16 v[80:95], v[228:231], v[164:167], v[80:95]
  v_cvt_pk_bf16_f32 v114, v100, v101
  v_cvt_pk_bf16_f32 v115, v102, v103
  v_exp_f32 v104, v104
  v_exp_f32 v105, v105
  v_exp_f32 v106, v106
  v_exp_f32 v107, v107
  v_mfma_f32_32x32x16_bf16 v[48:63], v[220:223], v[116:119], v[48:63]
  s_add_u32 s57, s57, 65536
  v_cvt_pk_bf16_f32 v116, v104, v105
  v_cvt_pk_bf16_f32 v117, v106, v107
  v_exp_f32 v108, v108
  v_exp_f32 v109, v109
  v_exp_f32 v110, v110
  v_exp_f32 v111, v111
  v_mfma_f32_32x32x16_bf16 v[64:79], v[216:219], v[112:115], v[64:79]
  v_cvt_pk_bf16_f32 v118, v108, v109
  v_cvt_pk_bf16_f32 v119, v110, v111
  v_exp_f32 v80, v80
  v_exp_f32 v81, v81
  v_exp_f32 v82, v82
  v_exp_f32 v83, v83
  v_mfma_f32_32x32x16_bf16 v[96:111], v[224:227], v[168:171], 0
  buffer_load_dwordx4 v[208:211], v0, s[44:47], s57 offen offset:0 sc1
  v_cvt_pk_bf16_f32 v112, v80, v81
  v_cvt_pk_bf16_f32 v113, v82, v83
  v_exp_f32 v84, v84
  v_exp_f32 v85, v85
  v_exp_f32 v86, v86
  v_exp_f32 v87, v87
  v_mfma_f32_32x32x16_bf16 v[96:111], v[228:231], v[172:175], v[96:111]
  v_cvt_pk_bf16_f32 v114, v84, v85
  v_cvt_pk_bf16_f32 v115, v86, v87
  v_exp_f32 v88, v88
  v_exp_f32 v89, v89
  v_exp_f32 v90, v90
  v_exp_f32 v91, v91
  v_mfma_f32_32x32x16_bf16 v[64:79], v[220:223], v[116:119], v[64:79]
  v_cvt_pk_bf16_f32 v116, v88, v89
  v_cvt_pk_bf16_f32 v117, v90, v91
  v_exp_f32 v92, v92
  v_exp_f32 v93, v93
  v_exp_f32 v94, v94
  v_exp_f32 v95, v95
  v_mfma_f32_32x32x16_bf16 v[16:31], v[232:235], v[112:115], v[16:31]
  v_cvt_pk_bf16_f32 v118, v92, v93
  v_cvt_pk_bf16_f32 v119, v94, v95
  v_exp_f32 v96, v96
  v_exp_f32 v97, v97
  v_exp_f32 v98, v98
  v_exp_f32 v99, v99
  v_mfma_f32_32x32x16_bf16 v[80:95], v[224:227], v[176:179], 0
  buffer_load_dwordx4 v[212:215], v0, s[44:47], s57 offen offset:1024 sc1
  v_cvt_pk_bf16_f32 v112, v96, v97
  v_cvt_pk_bf16_f32 v113, v98, v99
  v_exp_f32 v100, v100
  v_exp_f32 v101, v101
  v_exp_f32 v102, v102
  v_exp_f32 v103, v103
  v_mfma_f32_32x32x16_bf16 v[80:95], v[228:231], v[180:183], v[80:95]
  buffer_load_dwordx4 v[216:219], v2, s[44:47], s57 offen sc1
  v_cvt_pk_bf16_f32 v114, v100, v101
  v_cvt_pk_bf16_f32 v115, v102, v103
  v_exp_f32 v104, v104
  v_exp_f32 v105, v105
  v_exp_f32 v106, v106
  v_exp_f32 v107, v107
  v_mfma_f32_32x32x16_bf16 v[16:31], v[236:239], v[116:119], v[16:31]
  v_cvt_pk_bf16_f32 v116, v104, v105
  v_cvt_pk_bf16_f32 v117, v106, v107
  v_exp_f32 v108, v108
  v_exp_f32 v109, v109
  v_exp_f32 v110, v110
  v_exp_f32 v111, v111
  v_mfma_f32_32x32x16_bf16 v[32:47], v[232:235], v[112:115], v[32:47]
  v_cvt_pk_bf16_f32 v118, v108, v109
  v_cvt_pk_bf16_f32 v119, v110, v111
  v_exp_f32 v80, v80
  v_exp_f32 v81, v81
  v_exp_f32 v82, v82
  v_exp_f32 v83, v83
  v_mfma_f32_32x32x16_bf16 v[96:111], v[224:227], v[184:187], 0
  v_cvt_pk_bf16_f32 v112, v80, v81
  v_cvt_pk_bf16_f32 v113, v82, v83
  v_exp_f32 v84, v84
  v_exp_f32 v85, v85
  v_exp_f32 v86, v86
  v_exp_f32 v87, v87
  v_mfma_f32_32x32x16_bf16 v[96:111], v[228:231], v[188:191], v[96:111]
  buffer_load_dwordx4 v[220:223], v3, s[44:47], s57 offen sc1
  v_cvt_pk_bf16_f32 v114, v84, v85
  v_cvt_pk_bf16_f32 v115, v86, v87
  v_exp_f32 v88, v88
  v_exp_f32 v89, v89
  v_exp_f32 v90, v90
  v_exp_f32 v91, v91
  v_mfma_f32_32x32x16_bf16 v[32:47], v[236:239], v[116:119], v[32:47]
  v_cvt_pk_bf16_f32 v116, v88, v89
  v_cvt_pk_bf16_f32 v117, v90, v91
  v_exp_f32 v92, v92
  v_exp_f32 v93, v93
  v_exp_f32 v94, v94
  v_exp_f32 v95, v95
  v_mfma_f32_32x32x16_bf16 v[48:63], v[232:235], v[112:115], v[48:63]
  s_waitcnt vmcnt(8)
  v_cvt_pk_bf16_f32 v118, v92, v93
  v_cvt_pk_bf16_f32 v119, v94, v95
  v_exp_f32 v96, v96
  v_exp_f32 v97, v97
  v_exp_f32 v98, v98
  v_exp_f32 v99, v99
  v_mfma_f32_32x32x16_bf16 v[80:95], v[240:243], v[160:163], 0
  v_cvt_pk_bf16_f32 v112, v96, v97
  v_cvt_pk_bf16_f32 v113, v98, v99
  v_exp_f32 v100, v100
  v_exp_f32 v101, v101
  v_exp_f32 v102, v102
  v_exp_f32 v103, v103
  v_mfma_f32_32x32x16_bf16 v[80:95], v[244:247], v[164:167], v[80:95]
  v_cvt_pk_bf16_f32 v114, v100, v101
  v_cvt_pk_bf16_f32 v115, v102, v103
  v_exp_f32 v104, v104
  v_exp_f32 v105, v105
  v_exp_f32 v106, v106
  v_exp_f32 v107, v107
  v_mfma_f32_32x32x16_bf16 v[48:63], v[236:239], v[116:119], v[48:63]
  s_add_u32 s57, s57, 65536
  v_cvt_pk_bf16_f32 v116, v104, v105
  v_cvt_pk_bf16_f32 v117, v106, v107
  v_exp_f32 v108, v108
  v_exp_f32 v109, v109
  v_exp_f32 v110, v110
  v_exp_f32 v111, v111
  v_mfma_f32_32x32x16_bf16 v[64:79], v[232:235], v[112:115], v[64:79]
  v_cvt_pk_bf16_f32 v118, v108, v109
  v_cvt_pk_bf16_f32 v119, v110, v111
  v_exp_f32 v80, v80
  v_exp_f32 v81, v81
  v_exp_f32 v82, v82
  v_exp_f32 v83, v83
  v_mfma_f32_32x32x16_bf16 v[96:111], v[240:243], v[168:171], 0
  buffer_load_dwordx4 v[224:227], v0, s[44:47], s57 offen offset:0 sc1
  v_cvt_pk_bf16_f32 v112, v80, v81
  v_cvt_pk_bf16_f32 v113, v82, v83
  v_exp_f32 v84, v84
  v_exp_f32 v85, v85
  v_exp_f32 v86, v86
  v_exp_f32 v87, v87
  v_mfma_f32_32x32x16_bf16 v[96:111], v[244:247], v[172:175], v[96:111]
  v_cvt_pk_bf16_f32 v114, v84, v85
  v_cvt_pk_bf16_f32 v115, v86, v87
  v_exp_f32 v88, v88
  v_exp_f32 v89, v89
  v_exp_f32 v90, v90
  v_exp_f32 v91, v91
  v_mfma_f32_32x32x16_bf16 v[64:79], v[236:239], v[116:119], v[64:79]
  v_cvt_pk_bf16_f32 v116, v88, v89
  v_cvt_pk_bf16_f32 v117, v90, v91
  v_exp_f32 v92, v92
  v_exp_f32 v93, v93
  v_exp_f32 v94, v94
  v_exp_f32 v95, v95
  v_mfma_f32_32x32x16_bf16 v[16:31], v[248:251], v[112:115], v[16:31]
  v_cvt_pk_bf16_f32 v118, v92, v93
  v_cvt_pk_bf16_f32 v119, v94, v95
  v_exp_f32 v96, v96
  v_exp_f32 v97, v97
  v_exp_f32 v98, v98
  v_exp_f32 v99, v99
  v_mfma_f32_32x32x16_bf16 v[80:95], v[240:243], v[176:179], 0
  buffer_load_dwordx4 v[228:231], v0, s[44:47], s57 offen offset:1024 sc1
  v_cvt_pk_bf16_f32 v112, v96, v97
  v_cvt_pk_bf16_f32 v113, v98, v99
  v_exp_f32 v100, v100
  v_exp_f32 v101, v101
  v_exp_f32 v102, v102
  v_exp_f32 v103, v103
  v_mfma_f32_32x32x16_bf16 v[80:95], v[244:247], v[180:183], v[80:95]
  buffer_load_dwordx4 v[232:235], v2, s[44:47], s57 offen sc1
  v_cvt_pk_bf16_f32 v114, v100, v101
  v_cvt_pk_bf16_f32 v115, v102, v103
  v_exp_f32 v104, v104
  v_exp_f32 v105, v105
  v_exp_f32 v106, v106
  v_exp_f32 v107, v107
  v_mfma_f32_32x32x16_bf16 v[16:31], v[252:255], v[116:119], v[16:31]
  s_cmp_lg_u32 s62, 1
  v_cvt_pk_bf16_f32 v116, v104, v105
  v_cvt_pk_bf16_f32 v117, v106, v107
  v_exp_f32 v108, v108
  v_exp_f32 v109, v109
  v_exp_f32 v110, v110
  v_exp_f32 v111, v111
  s_cbranch_scc1 L_top
  s_setprio 3
  v_mfma_f32_32x32x16_bf16 v[32:47], v[248:251], v[112:115], v[32:47]
  v_cvt_pk_bf16_f32 v118, v108, v109
  v_cvt_pk_bf16_f32 v119, v110, v111
  v_exp_f32 v80, v80
  v_exp_f32 v81, v81
  v_exp_f32 v82, v82
  v_exp_f32 v83, v83
  v_mfma_f32_32x32x16_bf16 v[96:111], v[240:243], v[184:187], 0
  ds_write_b128 v6, v[16:19] offset:0
  v_cvt_pk_bf16_f32 v112, v80, v81
  v_cvt_pk_bf16_f32 v113, v82, v83
  v_exp_f32 v84, v84
  v_exp_f32 v85, v85
  v_exp_f32 v86, v86
  v_exp_f32 v87, v87
  v_mfma_f32_32x32x16_bf16 v[96:111], v[244:247], v[188:191], v[96:111]
  ds_write_b128 v6, v[20:23] offset:1024
  v_cvt_pk_bf16_f32 v114, v84, v85
  v_cvt_pk_bf16_f32 v115, v86, v87
  v_exp_f32 v88, v88
  v_exp_f32 v89, v89
  v_exp_f32 v90, v90
  v_exp_f32 v91, v91
  v_mfma_f32_32x32x16_bf16 v[32:47], v[252:255], v[116:119], v[32:47]
  ds_write_b128 v6, v[24:27] offset:2048
  ds_write_b128 v6, v[28:31] offset:3072
  v_cvt_pk_bf16_f32 v116, v88, v89
  v_cvt_pk_bf16_f32 v117, v90, v91
  v_exp_f32 v92, v92
  v_exp_f32 v93, v93
  v_exp_f32 v94, v94
  v_exp_f32 v95, v95
  v_mfma_f32_32x32x16_bf16 v[48:63], v[248:251], v[112:115], v[48:63]
  v_cvt_pk_bf16_f32 v118, v92, v93
  v_cvt_pk_bf16_f32 v119, v94, v95
  v_exp_f32 v96, v96
  v_exp_f32 v97, v97
  v_exp_f32 v98, v98
  v_exp_f32 v99, v99
  ds_write_b128 v7, v[32:35] offset:4096
  v_cvt_pk_bf16_f32 v112, v96, v97
  v_cvt_pk_bf16_f32 v113, v98, v99
  v_exp_f32 v100, v100
  v_exp_f32 v101, v101
  v_exp_f32 v102, v102
  v_exp_f32 v103, v103
  ds_write_b128 v7, v[36:39] offset:5120
  v_cvt_pk_bf16_f32 v114, v100, v101
  v_cvt_pk_bf16_f32 v115, v102, v103
  v_exp_f32 v104, v104
  v_exp_f32 v105, v105
  v_exp_f32 v106, v106
  v_exp_f32 v107, v107
  v_mfma_f32_32x32x16_bf16 v[48:63], v[252:255], v[116:119], v[48:63]
  ds_write_b128 v7, v[40:43] offset:6144
  ds_write_b128 v7, v[44:47] offset:7168
  v_cvt_pk_bf16_f32 v116, v104, v105
  v_cvt_pk_bf16_f32 v117, v106, v107
  v_exp_f32 v108, v108
  v_exp_f32 v109, v109
  v_exp_f32 v110, v110
  v_exp_f32 v111, v111
  v_mfma_f32_32x32x16_bf16 v[64:79], v[248:251], v[112:115], v[64:79]
  v_cvt_pk_bf16_f32 v118, v108, v109
  v_cvt_pk_bf16_f32 v119, v110, v111
  s_nop 1
  v_mfma_f32_32x32x16_bf16 v[64:79], v[252:255], v[116:119], v[64:79]
  ds_write_b128 v8, v[48:51] offset:8192
  ds_write_b128 v8, v[52:55] offset:9216
  ds_write_b128 v8, v[56:59] offset:10240
  ds_write_b128 v8, v[60:63] offset:11264
  s_mul_i32 s57, s28, 12288
  s_add_u32 s57, s57, 0
  v_add_u32 v6, s57, v13
  s_waitcnt lgkmcnt(0)
  s_barrier
  ds_read_b128 v[16:19], v6 offset:0
  ds_read_b128 v[20:23], v6 offset:1024
  ds_read_b128 v[24:27], v6 offset:2048
  ds_read_b128 v[28:31], v6 offset:3072
  ds_read_b128 v[32:35], v6 offset:4096
  ds_read_b128 v[36:39], v6 offset:5120
  ds_read_b128 v[40:43], v6 offset:6144
  ds_read_b128 v[44:47], v6 offset:7168
  ds_read_b128 v[48:51], v6 offset:8192
  ds_read_b128 v[52:55], v6 offset:9216
  ds_read_b128 v[56:59], v6 offset:10240
  ds_read_b128 v[60:63], v6 offset:11264
  s_waitcnt lgkmcnt(8)
  v_pk_add_f32 v[64:65], v[64:65], v[16:17]
  v_pk_add_f32 v[66:67], v[66:67], v[18:19]
  v_pk_add_f32 v[68:69], v[68:69], v[20:21]
  v_pk_add_f32 v[70:71], v[70:71], v[22:23]
  v_pk_add_f32 v[72:73], v[72:73], v[24:25]
  v_pk_add_f32 v[74:75], v[74:75], v[26:27]
  v_pk_add_f32 v[76:77], v[76:77], v[28:29]
  v_pk_add_f32 v[78:79], v[78:79], v[30:31]
  s_waitcnt lgkmcnt(4)
  v_pk_add_f32 v[64:65], v[64:65], v[32:33]
  v_pk_add_f32 v[66:67], v[66:67], v[34:35]
  v_pk_add_f32 v[68:69], v[68:69], v[36:37]
  v_pk_add_f32 v[70:71], v[70:71], v[38:39]
  v_pk_add_f32 v[72:73], v[72:73], v[40:41]
  v_pk_add_f32 v[74:75], v[74:75], v[42:43]
  v_pk_add_f32 v[76:77], v[76:77], v[44:45]
  v_pk_add_f32 v[78:79], v[78:79], v[46:47]
  s_waitcnt lgkmcnt(0)
  v_pk_add_f32 v[64:65], v[64:65], v[48:49]
  v_pk_add_f32 v[66:67], v[66:67], v[50:51]
  v_pk_add_f32 v[68:69], v[68:69], v[52:53]
  v_pk_add_f32 v[70:71], v[70:71], v[54:55]
  v_pk_add_f32 v[72:73], v[72:73], v[56:57]
  v_pk_add_f32 v[74:75], v[74:75], v[58:59]
  v_pk_add_f32 v[76:77], v[76:77], v[60:61]
  v_pk_add_f32 v[78:79], v[78:79], v[62:63]
  v_mov_b32 v8, v76
  v_mov_b32 v9, v76
  v_pk_add_f32 v[16:17], v[64:65], v[66:67]
  s_nop 0
  v_permlane32_swap_b32 v8, v9
  v_pk_add_f32 v[16:17], v[16:17], v[68:69]
  v_pk_add_f32 v[16:17], v[16:17], v[70:71]
  v_pk_add_f32 v[16:17], v[16:17], v[72:73]
  v_pk_add_f32 v[16:17], v[16:17], v[74:75]
  v_pk_add_f32 v[16:17], v[16:17], v[76:77]
  v_pk_add_f32 v[16:17], v[16:17], v[78:79]
  v_add_f32 v16, v16, v17
  v_mov_b32 v17, 0x1f8
  s_mov_b32 s56, 0x21800000
  s_mov_b32 s57, 0x53800000
  v_cmp_class_f32 vcc, v16, v17
  v_cmp_le_f32 s[58:59], s56, v9
  v_cmp_ge_f32 s[62:63], s57, v9
  s_and_b64 vcc, vcc, s[58:59]
  s_and_b64 vcc, vcc, s[62:63]
  s_cmp_eq_u64 vcc, -1
  s_cbranch_scc0 L_fb
L_norm:
  v_rcp_f32 v8, v9
  s_nop 0
  v_pk_mul_f32 v[64:65], v[64:65], v[8:9] op_sel_hi:[1,0]
  v_pk_mul_f32 v[66:67], v[66:67], v[8:9] op_sel_hi:[1,0]
  v_pk_mul_f32 v[68:69], v[68:69], v[8:9] op_sel_hi:[1,0]
  v_pk_mul_f32 v[70:71], v[70:71], v[8:9] op_sel_hi:[1,0]
  v_pk_mul_f32 v[72:73], v[72:73], v[8:9] op_sel_hi:[1,0]
  v_pk_mul_f32 v[74:75], v[74:75], v[8:9] op_sel_hi:[1,0]
  v_pk_mul_f32 v[76:77], v[76:77], v[8:9] op_sel_hi:[1,0]
  v_pk_mul_f32 v[78:79], v[78:79], v[8:9] op_sel_hi:[1,0]
  v_cvt_pk_bf16_f32 v112, v64, v65
  v_cvt_pk_bf16_f32 v113, v66, v67
  v_cvt_pk_bf16_f32 v114, v68, v69
  v_cvt_pk_bf16_f32 v115, v70, v71
  v_cvt_pk_bf16_f32 v116, v72, v73
  v_cvt_pk_bf16_f32 v117, v74, v75
  v_cvt_pk_bf16_f32 v118, v76, v77
  v_cvt_pk_bf16_f32 v119, v78, v79
  v_cndmask_b32 v118, 0, v118, s[60:61]
  v_cndmask_b32 v119, 0, v119, s[60:61]
  buffer_store_dwordx4 v[112:115], v13, s[32:35], s55 offen offset:0 sc1
  buffer_store_dwordx4 v[116:119], v13, s[32:35], s55 offen offset:1024 sc1
  s_endpgm
L_hot_end:
L_fb:
  s_waitcnt vmcnt(0)
  s_lshl_b32 s52, s28, 20
  v_subrev_u32 v0, s52, v0
  v_subrev_u32 v2, s52, v2
  v_subrev_u32 v3, s52, v3
  s_mov_b32 s56, 0x400000
  s_mov_b32 s57, 0
  v_mov_b32 v8, 0xff800000
L_fb1:
  buffer_load_dwordx4 v[192:195], v0, s[32:35], s57 offen offset:0 sc1
  buffer_load_dwordx4 v[196:199], v0, s[32:35], s57 offen offset:1024 sc1
  s_waitcnt vmcnt(0)
  v_mfma_f32_32x32x16_bf16 v[80:95], v[192:195], v[184:187], 0
  v_mfma_f32_32x32x16_bf16 v[80:95], v[196:199], v[188:191], v[80:95]
  s_nop 11
  v_max3_f32 v8, v8, v80, v81
  v_max3_f32 v8, v8, v82, v83
  v_max3_f32 v8, v8, v84, v85
  v_max3_f32 v8, v8, v86, v87
  v_max3_f32 v8, v8, v88, v89
  v_max3_f32 v8, v8, v90, v91
  v_max3_f32 v8, v8, v92, v93
  v_max3_f32 v8, v8, v94, v95
  s_add_u32 s57, s57, 0x10000
  s_cmp_lt_u32 s57, s56
  s_cbranch_scc1 L_fb1
  v_mov_b32 v9, v8
  s_nop 1
  v_permlane32_swap_b32 v8, v9
  v_max_f32 v8, v8, v9
  s_mov_b32 s57, 0
  v_mov_b32 v64, 0
  v_mov_b32 v65, 0
  v_mov_b32 v66, 0
  v_mov_b32 v67, 0
  v_mov_b32 v68, 0
  v_mov_b32 v69, 0
  v_mov_b32 v70, 0
  v_mov_b32 v71, 0
  v_mov_b32 v72, 0
  v_mov_b32 v73, 0
  v_mov_b32 v74, 0
  v_mov_b32 v75, 0
  v_mov_b32 v76, 0
  v_mov_b32 v77, 0
  v_mov_b32 v78, 0
  v_mov_b32 v79, 0
L_fb2:
  buffer_load_dwordx4 v[192:195], v0, s[32:35], s57 offen offset:0 sc1
  buffer_load_dwordx4 v[196:199], v0, s[32:35], s57 offen offset:1024 sc1
  buffer_load_dwordx4 v[200:203], v2, s[32:35], s57 offen sc1
  buffer_load_dwordx4 v[204:207], v3, s[32:35], s57 offen sc1
  s_waitcnt vmcnt(0)
  v_mfma_f32_32x32x16_bf16 v[80:95], v[192:195], v[184:187], 0
  v_mfma_f32_32x32x16_bf16 v[80:95], v[196:199], v[188:191], v[80:95]
  s_nop 11
  v_sub_f32 v80, v80, v8
  v_sub_f32 v81, v81, v8
  v_sub_f32 v82, v82, v8
  v_sub_f32 v83, v83, v8
  v_sub_f32 v84, v84, v8
  v_sub_f32 v85, v85, v8
  v_sub_f32 v86, v86, v8
  v_sub_f32 v87, v87, v8
  v_sub_f32 v88, v88, v8
  v_sub_f32 v89, v89, v8
  v_sub_f32 v90, v90, v8
  v_sub_f32 v91, v91, v8
  v_sub_f32 v92, v92, v8
  v_sub_f32 v93, v93, v8
  v_sub_f32 v94, v94, v8
  v_sub_f32 v95, v95, v8
  v_exp_f32 v80, v80
  v_exp_f32 v81, v81
  v_exp_f32 v82, v82
  v_exp_f32 v83, v83
  v_exp_f32 v84, v84
  v_exp_f32 v85, v85
  v_exp_f32 v86, v86
  v_exp_f32 v87, v87
  v_exp_f32 v88, v88
  v_exp_f32 v89, v89
  v_exp_f32 v90, v90
  v_exp_f32 v91, v91
  v_exp_f32 v92, v92
  v_exp_f32 v93, v93
  v_exp_f32 v94, v94
  v_exp_f32 v95, v95
  v_cvt_pk_bf16_f32 v112, v80, v81
  v_cvt_pk_bf16_f32 v113, v82, v83
  v_cvt_pk_bf16_f32 v114, v84, v85
  v_cvt_pk_bf16_f32 v115, v86, v87
  v_cvt_pk_bf16_f32 v116, v88, v89
  v_cvt_pk_bf16_f32 v117, v90, v91
  v_cvt_pk_bf16_f32 v118, v92, v93
  v_cvt_pk_bf16_f32 v119, v94, v95
  v_mfma_f32_32x32x16_bf16 v[64:79], v[200:203], v[112:115], v[64:79]
  s_nop 0
  v_mfma_f32_32x32x16_bf16 v[64:79], v[204:207], v[116:119], v[64:79]
  s_add_u32 s57, s57, 0x10000
  s_cmp_lt_u32 s57, s56
  s_cbranch_scc1 L_fb2
  s_nop 15
  v_mov_b32 v8, v76
  v_mov_b32 v9, v76
  s_nop 1
  v_permlane32_swap_b32 v8, v9
  s_nop 1
  s_branch L_norm

.section .rodata,"a"
.p2align 6
.amdhsa_kernel concat_heads__softmax_full_mha__ssm_conv_h3__prompt_kernel
  .amdhsa_next_free_vgpr 256
  .amdhsa_next_free_sgpr 102
  .amdhsa_accum_offset 256
  .amdhsa_group_segment_fixed_size 0
  .amdhsa_kernarg_size 96
  .amdhsa_user_sgpr_count 2
  .amdhsa_user_sgpr_kernarg_segment_ptr 1
  .amdhsa_system_sgpr_workgroup_id_x 1
.end_amdhsa_kernel
```
